```python
import torch

def _softmax(x, axis=-1):
    return torch.softmax(x, dim=axis)
def _gelu(x):
    return torch.nn.functional.gelu(x, approximate="tanh")
def _silu(x):
    return torch.nn.functional.silu(x)
def _sigmoid(x):
    return torch.sigmoid(x)
def _layernorm(x, axis=-1, eps=1e-5):
    m = x.mean(dim=axis, keepdim=True)
    v = x.var(dim=axis, keepdim=True, unbiased=False)
    return (x - m) / torch.sqrt(v + eps)
def _scatter_add(tgt, idx, src, axis=0):
    return tgt.clone().index_add_(axis, idx, src)
def _segment_sum(src, seg, n):
    out = torch.zeros((n,) + src.shape[1:], dtype=src.dtype)
    return out.index_add_(0, seg, src)
def _pad(x, pw):
    flat = tuple(v for pair in reversed(pw) for v in pair)
    return torch.nn.functional.pad(x, flat)

kernel_name = 'standalone__paged_block_table_kv_radixattention__sampling'

def setup_inputs():

    _w = (lambda a: (lambda t: t.to(torch.bfloat16) if t.is_floating_point() else t)(torch.as_tensor(a)))
    B, H, Hkv, Dh = 32, 32, 16, 128
    Lk = 2048
    bs = 16
    nb = max(2, Lk // bs)
    P = max(1, nb // 2)
    n_phys = P + B * (nb - P)
    shared = torch.arange(P, dtype=torch.int64)
    priv = P + torch.arange(B * (nb - P), dtype=torch.int64).reshape(B, nb - P)
    bt = torch.cat([torch.tile(shared[None, :], (B, 1)), priv], dim=1)
    ctx = nb * bs - (torch.arange(1, B + 1, dtype=torch.int64) * 2654435761) % max(1, (nb * bs - P * bs) // 2)
    return {
        "q": _w((lambda *s: torch.randn(*s, dtype=torch.bfloat16) * 0.8)(B, H, Dh)),
        "k_cache": _w((lambda *s: torch.randn(*s, dtype=torch.bfloat16) * 0.8)(n_phys, bs, Hkv, Dh)),
        "v_cache": _w((lambda *s: torch.randn(*s, dtype=torch.bfloat16) * 0.05)(n_phys, bs, Hkv, Dh)),
        "block_table": _w(bt.to(torch.int64)),
        "ctx_lens": _w(torch.as_tensor(ctx).to(torch.int64)),
    }

def reference(q, k_cache, v_cache, block_table, ctx_lens):
    B, H, Dh = q.shape
    n_phys, bs, Hkv, _ = k_cache.shape
    nb = block_table.shape[1]
    Lk = nb * bs
    rep = H // Hkv
    k = k_cache[block_table].reshape(B, Lk, Hkv, Dh)
    v = v_cache[block_table].reshape(B, Lk, Hkv, Dh)
    k = (lambda x, n, axis: torch.repeat_interleave(x, n, dim=axis))(k, rep, axis=2)
    v = (lambda x, n, axis: torch.repeat_interleave(x, n, dim=axis))(v, rep, axis=2)
    scores = torch.einsum("bhd,bkhd->bhk", q, k) * (Dh ** -0.5)
    pos = torch.arange(Lk)
    valid = pos[None, :] < ctx_lens[:, None]
    scores = torch.where(valid[:, None, :], scores, -1e9)
    p = _softmax(scores, axis=-1)
    return torch.einsum("bhk,bkhd->bhd", p, v)
```

```asm
; @launch grid=(256,1,1) block=(256,1,1) lds=8320
.amdgcn_target "amdgcn-amd-amdhsa--gfx950"
.text
.globl standalone__paged_block_table_kv_radixattention__sampling_kernel
.p2align 8
.type standalone__paged_block_table_kv_radixattention__sampling_kernel,@function
standalone__paged_block_table_kv_radixattention__sampling_kernel:
    s_cmp_ge_u32 s2, 256
    s_cbranch_scc1 L_end
    s_load_dwordx16 s[4:19], s[0:1], 0
    v_lshrrev_b32 v10, 6, v0
    v_and_b32 v1, 63, v0
    s_and_b32 s56, s2, 7
    s_lshl_b32 s56, s56, 2
    s_lshr_b32 s52, 0xeca86420, s56
    s_and_b32 s52, s52, 15
    s_bitcmp1_b32 s2, 3
    s_cselect_b32 s77, 1, 0
    s_xor_b32 s52, s52, s77
    v_readfirstlane_b32 s57, v10
    s_lshr_b32 s54, s2, 6
    s_bfe_u32 s55, s2, 0x20004
    s_mov_b32 s58, 0x17031f05
    s_cmp_eq_u32 s54, 1
    s_cselect_b32 s58, 0x1009120b, s58
    s_cmp_eq_u32 s54, 2
    s_cselect_b32 s58, 0x161d1804, s58
    s_cmp_eq_u32 s54, 3
    s_cselect_b32 s58, 0x1c1e110a, s58
    s_lshl_b32 s82, s55, 3
    s_lshr_b32 s60, s58, s82
    s_and_b32 s60, s60, 31
    s_add_u32 s77, s60, 1
    s_mul_i32 s77, s77, 433
    s_and_b32 s77, s77, 511
    s_sub_u32 s77, 2047, s77
    s_and_b32 s75, s77, 15
    s_add_u32 s75, s75, 1
    s_lshr_b32 s77, s77, 4
    s_lshl_b32 s78, s60, 6
    s_add_u32 s77, s77, s78
    s_sub_u32 s77, s77, s57
    s_mov_b32 s63, 0x30210f00
    s_mov_b32 s78, 0x2f200f00
    s_bitcmp1_b32 s2, 3
    s_cselect_b32 s63, 0x10003022, s63
    s_cselect_b32 s78, 0xf002f20, s78
    s_bitcmp1_b32 s2, 0
    s_cselect_b32 s63, s78, s63
    s_lshr_b32 s63, s63, s82
    s_and_b32 s63, s63, 0xff
    s_xor_b32 s53, s52, 1
    s_cmp_eq_u32 s57, 3
    s_cselect_b32 s77, s63, s77
    s_cselect_b32 s3, s53, s52
    s_lshl_b32 s3, s3, 8
    s_lshl_b32 s77, s77, 16
    s_add_u32 s73, s77, s3
    s_cmp_eq_u32 s57, 0
    s_cselect_b32 s75, s75, 16
    v_lshrrev_b32 v20, 4, v1
    v_and_b32 v11, 3, v1
    v_lshl_add_u32 v10, v20, 2, v11
    v_lshlrev_b32 v10, 4, v10
    v_bfe_u32 v11, v1, 2, 2
    v_lshl_add_u32 v2, v11, 12, v10
    v_and_b32 v11, 15, v1
    v_lshlrev_b32 v11, 4, v11
    v_lshl_add_u32 v3, v20, 12, v11
    s_mov_b32 s22, 0x8400000
    s_mov_b32 s23, 0x20000
    s_mov_b32 s26, 0x8400000
    s_mov_b32 s27, 0x20000
    s_mov_b32 s79, s73
    s_mov_b32 s81, s75
    s_cmp_gt_u32 s81, 0
    s_cselect_b32 s84, s79, 0xf0000000
    s_add_u32 s79, s79, 0x4000
    s_cmp_gt_u32 s81, 4
    s_cselect_b32 s85, s79, 0xf0000000
    s_add_u32 s79, s79, 0x4000
    s_cmp_gt_u32 s81, 8
    s_cselect_b32 s86, s79, 0xf0000000
    s_add_u32 s79, s79, 0x4000
    s_cmp_gt_u32 s81, 12
    s_cselect_b32 s87, s79, 0xf0000000
    s_waitcnt lgkmcnt(0)
    s_mov_b64 s[20:21], s[6:7]
    s_mov_b64 s[24:25], s[8:9]
    buffer_load_dwordx4 v[124:127], v2, s[20:23], s84 offen nt
    buffer_load_dwordx4 v[128:131], v2, s[20:23], s85 offen nt
    buffer_load_dwordx4 v[132:135], v2, s[20:23], s86 offen nt
    buffer_load_dwordx4 v[136:139], v2, s[20:23], s87 offen nt
    buffer_load_dwordx4 v[140:143], v3, s[24:27], s84 offen nt
    buffer_load_dwordx4 v[144:147], v3, s[24:27], s85 offen nt
    buffer_load_dwordx4 v[148:151], v3, s[24:27], s86 offen nt
    buffer_load_dwordx4 v[152:155], v3, s[24:27], s87 offen nt
    s_mov_b64 s[36:37], s[12:13]
    s_mov_b64 s[32:33], s[10:11]
    s_mov_b32 s38, 0x80
    s_mov_b32 s39, 0x20000
    s_mov_b32 s34, 0x4000
    s_mov_b32 s35, 0x20000
    v_and_b32 v11, 31, v1
    v_lshlrev_b32 v32, 2, v11
    v_lshlrev_b32 v35, 3, v1
    s_mov_b32 s59, 0x14080c06
    s_mov_b32 s76, 0x80901168
    s_cmp_eq_u32 s54, 1
    s_cselect_b32 s59, 0x1b021900, s59
    s_cselect_b32 s76, 0xa050a05, s76
    s_cmp_eq_u32 s54, 2
    s_cselect_b32 s59, 0x150e1307, s59
    s_cselect_b32 s76, 0x21684090, s76
    s_cmp_eq_u32 s54, 3
    s_cselect_b32 s59, 0xf0d1a01, s59
    s_cselect_b32 s76, 0x5402a402, s76
    buffer_load_dword v6, v32, s[36:39], 0 offen
    s_mov_b32 s78, s58
    s_mov_b32 s79, s58
    s_mov_b32 s80, s59
    s_mov_b32 s81, s59
    s_lshr_b64 s[78:79], s[78:79], s82
    s_lshr_b64 s[80:81], s[80:81], s82
    s_and_b32 s61, s80, 31
    s_bfe_u32 s88, s78, 0x50000
    s_lshl_b32 s88, s88, 9
    buffer_load_dwordx2 v[72:73], v35, s[32:35], s88 offen
    s_bfe_u32 s89, s80, 0x50000
    s_lshl_b32 s89, s89, 9
    buffer_load_dwordx2 v[74:75], v35, s[32:35], s89 offen
    s_bfe_u32 s90, s78, 0x50008
    s_lshl_b32 s90, s90, 9
    buffer_load_dwordx2 v[76:77], v35, s[32:35], s90 offen
    s_bfe_u32 s91, s80, 0x50008
    s_lshl_b32 s91, s91, 9
    buffer_load_dwordx2 v[78:79], v35, s[32:35], s91 offen
    s_bfe_u32 s92, s78, 0x50010
    s_lshl_b32 s92, s92, 9
    buffer_load_dwordx2 v[80:81], v35, s[32:35], s92 offen
    s_bfe_u32 s93, s80, 0x50010
    s_lshl_b32 s93, s93, 9
    buffer_load_dwordx2 v[82:83], v35, s[32:35], s93 offen
    s_bfe_u32 s94, s78, 0x50018
    s_lshl_b32 s94, s94, 9
    buffer_load_dwordx2 v[84:85], v35, s[32:35], s94 offen
    s_bfe_u32 s95, s80, 0x50018
    s_lshl_b32 s95, s95, 9
    buffer_load_dwordx2 v[86:87], v35, s[32:35], s95 offen
    s_mov_b64 s[28:29], s[4:5]
    s_mov_b64 s[40:41], s[14:15]
    s_mov_b64 s[48:49], s[16:17]
    s_mov_b64 s[44:45], s[18:19]
    s_mov_b32 s30, 0x40000
    s_mov_b32 s31, 0x20000
    s_mov_b32 s42, 0x40000
    s_mov_b32 s43, 0x20000
    s_mov_b32 s46, 0x800000
    s_mov_b32 s47, 0x20000
    s_mov_b32 s50, 0x100
    s_mov_b32 s51, 0x20000
    s_or_b32 s56, s56, s54
    s_lshl_b32 s5, s53, 8
    s_cmp_eq_u32 s57, 3
    s_cbranch_scc1 L_sprolog
    v_bfe_u32 v11, v1, 3, 1
    v_lshl_add_u32 v36, v11, 8, v10
    s_lshl_b32 s77, s60, 13
    s_lshl1_add_u32 s96, s3, s77
    s_lshl_b32 s77, s61, 13
    s_lshl1_add_u32 s97, s5, s77
    buffer_load_dwordx4 v[24:27], v36, s[28:31], s96 offen nt
    buffer_load_dwordx4 v[28:31], v36, s[28:31], s97 offen nt
    s_cmp_eq_u32 s57, 3
    s_cselect_b32 s77, 1, -3
    s_lshl_b32 s77, s77, 16
    s_add_u32 s74, s73, s77
    s_mov_b32 s84, s74
    s_add_u32 s85, s84, 0x4000
    s_add_u32 s86, s84, 0x8000
    s_add_u32 s87, s84, 0xc000
    buffer_load_dwordx4 v[156:159], v2, s[20:23], s84 offen nt
    buffer_load_dwordx4 v[160:163], v2, s[20:23], s85 offen nt
    buffer_load_dwordx4 v[164:167], v2, s[20:23], s86 offen nt
    buffer_load_dwordx4 v[168:171], v2, s[20:23], s87 offen nt
    buffer_load_dwordx4 v[172:175], v3, s[24:27], s84 offen nt
    buffer_load_dwordx4 v[176:179], v3, s[24:27], s85 offen nt
    buffer_load_dwordx4 v[180:183], v3, s[24:27], s86 offen nt
    buffer_load_dwordx4 v[184:187], v3, s[24:27], s87 offen nt
    s_waitcnt vmcnt(8)
L_common:
    v_min3_u32 v12, v72, v74, v76
    v_max3_u32 v14, v72, v74, v76
    v_min3_u32 v13, v73, v75, v77
    v_max3_u32 v15, v73, v75, v77
    v_cmp_lt_i32 vcc, 0, v6
    v_add_u32 v7, -1, v6
    v_min3_u32 v12, v12, v78, v80
    v_max3_u32 v14, v14, v78, v80
    v_min3_u32 v13, v13, v79, v81
    v_max3_u32 v15, v15, v79, v81
    v_min_u32 v7, 0x7ff, v7
    v_mov_b32 v10, 0x3e0293ee
    v_cndmask_b32 v6, 0, v10, vcc
    s_mov_b32 vcc_lo, s76
    s_mov_b32 vcc_hi, s76
    v_add_u32 v10, 1, v7
    v_lshrrev_b32 v10, 4, v10
    v_mov_b32 v11, 0x80
    v_cndmask_b32 v10, v11, v10, vcc
    v_min3_u32 v12, v12, v82, v84
    v_max3_u32 v14, v14, v82, v84
    v_min_u32_dpp v10, v10, v10 row_ror:8 row_mask:0xf bank_mask:0xf
    v_min3_u32 v13, v13, v83, v85
    v_max3_u32 v15, v15, v83, v85
    v_min_u32_dpp v10, v10, v10 row_ror:4 row_mask:0xf bank_mask:0xf
    v_min_u32 v12, v12, v86
    v_max_u32 v14, v14, v86
    v_min_u32_dpp v10, v10, v10 row_ror:2 row_mask:0xf bank_mask:0xf
    v_min_u32 v13, v13, v87
    v_max_u32 v15, v15, v87
    v_min_u32_dpp v10, v10, v10 row_ror:1 row_mask:0xf bank_mask:0xf
    v_cmp_ne_u32 s[88:89], v12, v14
    v_cmp_ne_u32 s[90:91], v13, v15
    v_lshl_or_b32 v4, v73, 16, v72
    v_lshl_or_b32 v5, v75, 16, v74
    v_readlane_b32 s62, v10, 0
    v_readlane_b32 s78, v10, 16
    v_readlane_b32 s65, v7, s60
    v_readlane_b32 s66, v7, s61
    v_readlane_b32 s69, v6, s60
    v_readlane_b32 s70, v6, s61
    s_ff1_i32_b64 s79, s[88:89]
    s_ff1_i32_b64 s80, s[90:91]
    s_lshl_b32 s79, s79, 1
    s_lshl1_add_u32 s80, s80, 1
    s_min_u32 s62, s62, s78
    s_min_u32 s79, s79, s80
    s_min_u32 s62, s62, s79
    s_and_b32 s67, s65, 15
    s_add_u32 s67, s67, 1
    s_lshr_b32 s65, s65, 4
    s_and_b32 s68, s66, 15
    s_add_u32 s68, s68, 1
    s_lshr_b32 s66, s66, 4
    s_cmp_eq_u32 s57, 3
    s_cbranch_scc1 L_shared
    s_sub_u32 s63, s65, s62
    s_add_u32 s63, s63, 1
    s_add_u32 s66, s66, s63
    s_sub_u32 s64, s66, s62
    s_add_u32 s64, s64, 1
    s_mov_b32 s71, s57
    s_mov_b32 s72, s57
    s_cmp_lt_u32 s71, s63
    s_cselect_b32 s77, s65, s66
    s_cselect_b32 s81, s67, s68
    s_cselect_b32 s82, 0, s63
    s_cselect_b32 s83, s3, s5
    s_sub_u32 s77, s77, s71
    s_bfe_u32 s78, s77, 0x60001
    v_readlane_b32 s79, v4, s78
    v_readlane_b32 s80, v5, s78
    s_cmp_lt_u32 s71, s63
    s_cselect_b32 s79, s79, s80
    s_lshl_b32 s80, s79, 16
    s_and_b32 s79, s79, 0xffff0000
    s_bitcmp1_b32 s77, 0
    s_cselect_b32 s79, s79, s80
    s_add_u32 s79, s79, s83
    s_cmp_eq_u32 s71, s82
    s_cselect_b32 s81, s81, 16
    s_cmp_lt_u32 s71, s64
    s_cselect_b32 s81, s81, 0
    s_add_u32 s71, s71, 3
    s_cmp_lg_u32 s79, s73
    s_cbranch_scc1 L_predo
    s_cmp_lg_u32 s81, s75
    s_cbranch_scc1 L_predo
    s_cmp_lt_u32 s71, s63
    s_cselect_b32 s77, s65, s66
    s_cselect_b32 s81, s67, s68
    s_cselect_b32 s82, 0, s63
    s_cselect_b32 s83, s3, s5
    s_sub_u32 s77, s77, s71
    s_bfe_u32 s78, s77, 0x60001
    v_readlane_b32 s79, v4, s78
    v_readlane_b32 s80, v5, s78
    s_cmp_lt_u32 s71, s63
    s_cselect_b32 s79, s79, s80
    s_lshl_b32 s80, s79, 16
    s_and_b32 s79, s79, 0xffff0000
    s_bitcmp1_b32 s77, 0
    s_cselect_b32 s79, s79, s80
    s_add_u32 s79, s79, s83
    s_cmp_eq_u32 s71, s82
    s_cselect_b32 s81, s81, 16
    s_cmp_lt_u32 s71, s64
    s_cselect_b32 s81, s81, 0
    s_add_u32 s71, s71, 3
    s_cmp_lg_u32 s79, s74
    s_cbranch_scc1 L_predo
    s_cmp_lg_u32 s81, 16
    s_cbranch_scc1 L_predo
L_pgo:
    v_and_b32 v10, 1, v1
    v_cmp_eq_u32 vcc, 0, v10
    v_mov_b32 v10, 0xffff0000
    v_mov_b32 v11, 0xffff
    v_cndmask_b32 v10, v10, v11, vcc
    v_bfe_u32 v11, v1, 1, 2
    v_cmp_eq_u32 vcc, 0, v11
    s_nop 1
    v_cndmask_b32 v16, 0, v10, vcc
    v_cmp_eq_u32 vcc, 1, v11
    s_nop 1
    v_cndmask_b32 v17, 0, v10, vcc
    v_cmp_eq_u32 vcc, 2, v11
    s_nop 1
    v_cndmask_b32 v18, 0, v10, vcc
    v_cmp_eq_u32 vcc, 3, v11
    s_nop 1
    v_cndmask_b32 v19, 0, v10, vcc
    s_lshl_b32 s77, s57, 10
    v_lshl_add_u32 v21, v1, 4, s77
    v_bfe_u32 v10, v1, 3, 1
    v_mul_u32_u24 v10, 32, v10
    s_lshl_b32 s77, s57, 2
    s_add_u32 s77, s77, 8192
    v_add_u32 v22, s77, v10
    v_mov_b32 v6, 0xf149f2ca
    v_mov_b32 v7, 0
    v_mov_b32 v40, 0
    v_mov_b32 v41, 0
    v_mov_b32 v42, 0
    v_mov_b32 v43, 0
    s_mov_b32 s76, s63
    s_mov_b32 s73, 0
    s_mov_b32 s74, s67
    s_mov_b32 s75, s69
L_ploop:
    s_cmp_ge_u32 s72, s64
    s_cbranch_scc1 L_pdone
    s_waitcnt vmcnt(12)
    s_cmp_ge_u32 s72, s76
    s_cbranch_scc1 L_psw0
L_pnosw0:
    v_mfma_f32_16x16x32_bf16 v[72:75], v[124:127], v[24:27], 0
    v_mfma_f32_16x16x32_bf16 v[76:79], v[128:131], v[24:27], 0
    v_mfma_f32_16x16x32_bf16 v[80:83], v[132:135], v[24:27], 0
    v_mfma_f32_16x16x32_bf16 v[84:87], v[136:139], v[24:27], 0
    s_cmp_lt_u32 s71, s63
    s_cselect_b32 s77, s65, s66
    s_cselect_b32 s81, s67, s68
    s_cselect_b32 s82, 0, s63
    s_cselect_b32 s83, s3, s5
    s_sub_u32 s77, s77, s71
    s_bfe_u32 s78, s77, 0x60001
    v_readlane_b32 s79, v4, s78
    v_readlane_b32 s80, v5, s78
    s_cmp_lt_u32 s71, s63
    s_cselect_b32 s79, s79, s80
    s_lshl_b32 s80, s79, 16
    s_and_b32 s79, s79, 0xffff0000
    s_bitcmp1_b32 s77, 0
    s_cselect_b32 s79, s79, s80
    s_add_u32 s79, s79, s83
    s_cmp_eq_u32 s71, s82
    s_cselect_b32 s81, s81, 16
    s_cmp_lt_u32 s71, s64
    s_cselect_b32 s81, s81, 0
    s_add_u32 s71, s71, 3
    s_cmp_gt_u32 s81, 0
    s_cselect_b32 s84, s79, 0xf0000000
    s_add_u32 s79, s79, 0x4000
    s_cmp_gt_u32 s81, 4
    s_cselect_b32 s85, s79, 0xf0000000
    s_add_u32 s79, s79, 0x4000
    s_cmp_gt_u32 s81, 8
    s_cselect_b32 s86, s79, 0xf0000000
    s_add_u32 s79, s79, 0x4000
    s_cmp_gt_u32 s81, 12
    s_cselect_b32 s87, s79, 0xf0000000
    buffer_load_dwordx4 v[124:127], v2, s[20:23], s84 offen nt
    buffer_load_dwordx4 v[128:131], v2, s[20:23], s85 offen nt
    buffer_load_dwordx4 v[132:135], v2, s[20:23], s86 offen nt
    buffer_load_dwordx4 v[136:139], v2, s[20:23], s87 offen nt
    v_mov_b32_dpp v12, v72 quad_perm:[0,0,0,0] row_mask:0xf bank_mask:0xf
    v_mov_b32_dpp v13, v76 quad_perm:[0,0,0,0] row_mask:0xf bank_mask:0xf
    v_mov_b32_dpp v14, v80 quad_perm:[0,0,0,0] row_mask:0xf bank_mask:0xf
    v_mov_b32_dpp v15, v84 quad_perm:[0,0,0,0] row_mask:0xf bank_mask:0xf
    v_add_f32_dpp v12, v73, v12 quad_perm:[1,1,1,1] row_mask:0xf bank_mask:0xf
    v_add_f32_dpp v13, v77, v13 quad_perm:[1,1,1,1] row_mask:0xf bank_mask:0xf
    v_add_f32_dpp v14, v81, v14 quad_perm:[1,1,1,1] row_mask:0xf bank_mask:0xf
    v_add_f32_dpp v15, v85, v15 quad_perm:[1,1,1,1] row_mask:0xf bank_mask:0xf
    v_add_f32_dpp v12, v74, v12 quad_perm:[2,2,2,2] row_mask:0xf bank_mask:0xf
    v_add_f32_dpp v13, v78, v13 quad_perm:[2,2,2,2] row_mask:0xf bank_mask:0xf
    v_add_f32_dpp v14, v82, v14 quad_perm:[2,2,2,2] row_mask:0xf bank_mask:0xf
    v_add_f32_dpp v15, v86, v15 quad_perm:[2,2,2,2] row_mask:0xf bank_mask:0xf
    v_add_f32_dpp v12, v75, v12 quad_perm:[3,3,3,3] row_mask:0xf bank_mask:0xf
    v_add_f32_dpp v13, v79, v13 quad_perm:[3,3,3,3] row_mask:0xf bank_mask:0xf
    v_add_f32_dpp v14, v83, v14 quad_perm:[3,3,3,3] row_mask:0xf bank_mask:0xf
    v_add_f32_dpp v15, v87, v15 quad_perm:[3,3,3,3] row_mask:0xf bank_mask:0xf
    s_cmp_eq_u32 s72, s73
    s_cbranch_scc1 L_pmask0
L_pnomask0:
    v_max3_f32 v10, v12, v13, v14
    v_max_f32 v10, v10, v15
    v_mov_b32 v11, v10
    s_nop 1
    v_permlane32_swap_b32 v10, v11
    s_nop 0
    v_max_f32 v10, v10, v11
    v_mov_b32 v11, v10
    s_nop 1
    v_permlane16_swap_b32 v10, v11
    s_nop 0
    v_max_f32 v10, v10, v11
    v_mul_f32 v10, s75, v10
    v_max_f32 v10, v10, v6
    v_sub_f32 v8, v6, v10
    v_fma_f32 v12, v12, s75, -v10
    v_fma_f32 v13, v13, s75, -v10
    v_fma_f32 v14, v14, s75, -v10
    v_fma_f32 v15, v15, s75, -v10
    v_exp_f32 v8, v8
    v_exp_f32 v12, v12
    v_exp_f32 v13, v13
    v_exp_f32 v14, v14
    v_exp_f32 v15, v15
    v_mov_b32 v6, v10
    v_add_f32 v10, v12, v13
    v_fma_f32 v7, v7, v8, v10
    v_add_f32 v10, v14, v15
    v_add_f32 v7, v7, v10
    v_pk_mul_f32 v[40:41], v[40:41], v[8:9] op_sel_hi:[1,0]
    v_pk_mul_f32 v[42:43], v[42:43], v[8:9] op_sel_hi:[1,0]
    v_cvt_pk_bf16_f32 v12, v12, v12
    v_cvt_pk_bf16_f32 v13, v13, v13
    v_cvt_pk_bf16_f32 v14, v14, v14
    v_cvt_pk_bf16_f32 v15, v15, v15
    v_and_b32 v72, v12, v16
    v_and_b32 v73, v12, v17
    v_and_b32 v74, v12, v18
    v_and_b32 v75, v12, v19
    v_and_b32 v76, v13, v16
    v_and_b32 v77, v13, v17
    v_and_b32 v78, v13, v18
    v_and_b32 v79, v13, v19
    v_and_b32 v80, v14, v16
    v_and_b32 v81, v14, v17
    v_and_b32 v82, v14, v18
    v_and_b32 v83, v14, v19
    v_and_b32 v84, v15, v16
    v_and_b32 v85, v15, v17
    v_and_b32 v86, v15, v18
    v_and_b32 v87, v15, v19
    s_add_u32 s72, s72, 3
    s_waitcnt vmcnt(12)
    v_mfma_f32_16x16x32_bf16 v[40:43], v[140:143], v[72:75], v[40:43]
    v_mfma_f32_16x16x32_bf16 v[40:43], v[144:147], v[76:79], v[40:43]
    v_mfma_f32_16x16x32_bf16 v[40:43], v[148:151], v[80:83], v[40:43]
    v_mfma_f32_16x16x32_bf16 v[40:43], v[152:155], v[84:87], v[40:43]
    buffer_load_dwordx4 v[140:143], v3, s[24:27], s84 offen nt
    buffer_load_dwordx4 v[144:147], v3, s[24:27], s85 offen nt
    buffer_load_dwordx4 v[148:151], v3, s[24:27], s86 offen nt
    buffer_load_dwordx4 v[152:155], v3, s[24:27], s87 offen nt
    s_cmp_ge_u32 s72, s64
    s_cbranch_scc1 L_pdone
    s_waitcnt vmcnt(12)
    s_cmp_ge_u32 s72, s76
    s_cbranch_scc1 L_psw1
L_pnosw1:
    v_mfma_f32_16x16x32_bf16 v[72:75], v[156:159], v[24:27], 0
    v_mfma_f32_16x16x32_bf16 v[76:79], v[160:163], v[24:27], 0
    v_mfma_f32_16x16x32_bf16 v[80:83], v[164:167], v[24:27], 0
    v_mfma_f32_16x16x32_bf16 v[84:87], v[168:171], v[24:27], 0
    s_cmp_lt_u32 s71, s63
    s_cselect_b32 s77, s65, s66
    s_cselect_b32 s81, s67, s68
    s_cselect_b32 s82, 0, s63
    s_cselect_b32 s83, s3, s5
    s_sub_u32 s77, s77, s71
    s_bfe_u32 s78, s77, 0x60001
    v_readlane_b32 s79, v4, s78
    v_readlane_b32 s80, v5, s78
    s_cmp_lt_u32 s71, s63
    s_cselect_b32 s79, s79, s80
    s_lshl_b32 s80, s79, 16
    s_and_b32 s79, s79, 0xffff0000
    s_bitcmp1_b32 s77, 0
    s_cselect_b32 s79, s79, s80
    s_add_u32 s79, s79, s83
    s_cmp_eq_u32 s71, s82
    s_cselect_b32 s81, s81, 16
    s_cmp_lt_u32 s71, s64
    s_cselect_b32 s81, s81, 0
    s_add_u32 s71, s71, 3
    s_cmp_gt_u32 s81, 0
    s_cselect_b32 s84, s79, 0xf0000000
    s_add_u32 s79, s79, 0x4000
    s_cmp_gt_u32 s81, 4
    s_cselect_b32 s85, s79, 0xf0000000
    s_add_u32 s79, s79, 0x4000
    s_cmp_gt_u32 s81, 8
    s_cselect_b32 s86, s79, 0xf0000000
    s_add_u32 s79, s79, 0x4000
    s_cmp_gt_u32 s81, 12
    s_cselect_b32 s87, s79, 0xf0000000
    buffer_load_dwordx4 v[156:159], v2, s[20:23], s84 offen nt
    buffer_load_dwordx4 v[160:163], v2, s[20:23], s85 offen nt
    buffer_load_dwordx4 v[164:167], v2, s[20:23], s86 offen nt
    buffer_load_dwordx4 v[168:171], v2, s[20:23], s87 offen nt
    v_mov_b32_dpp v12, v72 quad_perm:[0,0,0,0] row_mask:0xf bank_mask:0xf
    v_mov_b32_dpp v13, v76 quad_perm:[0,0,0,0] row_mask:0xf bank_mask:0xf
    v_mov_b32_dpp v14, v80 quad_perm:[0,0,0,0] row_mask:0xf bank_mask:0xf
    v_mov_b32_dpp v15, v84 quad_perm:[0,0,0,0] row_mask:0xf bank_mask:0xf
    v_add_f32_dpp v12, v73, v12 quad_perm:[1,1,1,1] row_mask:0xf bank_mask:0xf
    v_add_f32_dpp v13, v77, v13 quad_perm:[1,1,1,1] row_mask:0xf bank_mask:0xf
    v_add_f32_dpp v14, v81, v14 quad_perm:[1,1,1,1] row_mask:0xf bank_mask:0xf
    v_add_f32_dpp v15, v85, v15 quad_perm:[1,1,1,1] row_mask:0xf bank_mask:0xf
    v_add_f32_dpp v12, v74, v12 quad_perm:[2,2,2,2] row_mask:0xf bank_mask:0xf
    v_add_f32_dpp v13, v78, v13 quad_perm:[2,2,2,2] row_mask:0xf bank_mask:0xf
    v_add_f32_dpp v14, v82, v14 quad_perm:[2,2,2,2] row_mask:0xf bank_mask:0xf
    v_add_f32_dpp v15, v86, v15 quad_perm:[2,2,2,2] row_mask:0xf bank_mask:0xf
    v_add_f32_dpp v12, v75, v12 quad_perm:[3,3,3,3] row_mask:0xf bank_mask:0xf
    v_add_f32_dpp v13, v79, v13 quad_perm:[3,3,3,3] row_mask:0xf bank_mask:0xf
    v_add_f32_dpp v14, v83, v14 quad_perm:[3,3,3,3] row_mask:0xf bank_mask:0xf
    v_add_f32_dpp v15, v87, v15 quad_perm:[3,3,3,3] row_mask:0xf bank_mask:0xf
    s_cmp_eq_u32 s72, s73
    s_cbranch_scc1 L_pmask1
L_pnomask1:
    v_max3_f32 v10, v12, v13, v14
    v_max_f32 v10, v10, v15
    v_mov_b32 v11, v10
    s_nop 1
    v_permlane32_swap_b32 v10, v11
    s_nop 0
    v_max_f32 v10, v10, v11
    v_mov_b32 v11, v10
    s_nop 1
    v_permlane16_swap_b32 v10, v11
    s_nop 0
    v_max_f32 v10, v10, v11
    v_mul_f32 v10, s75, v10
    v_max_f32 v10, v10, v6
    v_sub_f32 v8, v6, v10
    v_fma_f32 v12, v12, s75, -v10
    v_fma_f32 v13, v13, s75, -v10
    v_fma_f32 v14, v14, s75, -v10
    v_fma_f32 v15, v15, s75, -v10
    v_exp_f32 v8, v8
    v_exp_f32 v12, v12
    v_exp_f32 v13, v13
    v_exp_f32 v14, v14
    v_exp_f32 v15, v15
    v_mov_b32 v6, v10
    v_add_f32 v10, v12, v13
    v_fma_f32 v7, v7, v8, v10
    v_add_f32 v10, v14, v15
    v_add_f32 v7, v7, v10
    v_pk_mul_f32 v[40:41], v[40:41], v[8:9] op_sel_hi:[1,0]
    v_pk_mul_f32 v[42:43], v[42:43], v[8:9] op_sel_hi:[1,0]
    v_cvt_pk_bf16_f32 v12, v12, v12
    v_cvt_pk_bf16_f32 v13, v13, v13
    v_cvt_pk_bf16_f32 v14, v14, v14
    v_cvt_pk_bf16_f32 v15, v15, v15
    v_and_b32 v72, v12, v16
    v_and_b32 v73, v12, v17
    v_and_b32 v74, v12, v18
    v_and_b32 v75, v12, v19
    v_and_b32 v76, v13, v16
    v_and_b32 v77, v13, v17
    v_and_b32 v78, v13, v18
    v_and_b32 v79, v13, v19
    v_and_b32 v80, v14, v16
    v_and_b32 v81, v14, v17
    v_and_b32 v82, v14, v18
    v_and_b32 v83, v14, v19
    v_and_b32 v84, v15, v16
    v_and_b32 v85, v15, v17
    v_and_b32 v86, v15, v18
    v_and_b32 v87, v15, v19
    s_add_u32 s72, s72, 3
    s_waitcnt vmcnt(12)
    v_mfma_f32_16x16x32_bf16 v[40:43], v[172:175], v[72:75], v[40:43]
    v_mfma_f32_16x16x32_bf16 v[40:43], v[176:179], v[76:79], v[40:43]
    v_mfma_f32_16x16x32_bf16 v[40:43], v[180:183], v[80:83], v[40:43]
    v_mfma_f32_16x16x32_bf16 v[40:43], v[184:187], v[84:87], v[40:43]
    buffer_load_dwordx4 v[172:175], v3, s[24:27], s84 offen nt
    buffer_load_dwordx4 v[176:179], v3, s[24:27], s85 offen nt
    buffer_load_dwordx4 v[180:183], v3, s[24:27], s86 offen nt
    buffer_load_dwordx4 v[184:187], v3, s[24:27], s87 offen nt
    s_branch L_ploop
L_pdone:
    s_cmp_lg_u32 s76, -1
    s_cbranch_scc1 L_pnob
L_pfin:
    v_mov_b32 v11, v7
    s_nop 1
    v_permlane32_swap_b32 v7, v11
    s_nop 0
    v_add_f32 v7, v7, v11
    v_mov_b32 v11, v7
    s_nop 1
    v_permlane16_swap_b32 v7, v11
    s_nop 0
    v_add_f32 v7, v7, v11
    ds_write_b128 v21, v[40:43] offset:4096
    ds_write_b32 v22, v6 offset:64
    ds_write_b32 v22, v7 offset:80
L_final:
    s_lshr_b32 s77, s57, 1
    s_and_b32 s78, s57, 1
    s_mul_i32 s79, s77, 4096
    s_lshl_b32 s80, s78, 7
    s_add_u32 s79, s79, s80
    v_and_b32 v10, 3, v1
    v_lshlrev_b32 v10, 5, v10
    v_bfe_u32 v11, v1, 2, 2
    v_lshl_add_u32 v10, v11, 2, v10
    v_lshl_add_u32 v10, v20, 8, v10
    v_add_u32 v21, s79, v10
    v_add_u32 v22, 16, v21
    s_mul_i32 s80, s57, 32
    s_add_u32 s80, s80, 8192
    v_mov_b32 v10, s80
    s_cmp_eq_u32 s77, 0
    s_cselect_b32 s81, s60, s61
    s_cselect_b32 s82, s52, s53
    s_lshl_b32 s81, s81, 13
    s_lshl_b32 s82, s82, 9
    s_add_u32 s81, s81, s82
    s_lshl_b32 s82, s78, 8
    s_add_u32 s81, s81, s82
    v_lshlrev_b32 v11, 2, v1
    s_waitcnt lgkmcnt(0)
    s_barrier
    ds_read_b128 v[24:27], v10 offset:0
    ds_read_b128 v[32:35], v10 offset:16
    ds_read2st64_b32 v[40:41], v21 offset0:0 offset1:4
    ds_read2st64_b32 v[48:49], v22 offset0:0 offset1:4
    ds_read2st64_b32 v[42:43], v21 offset0:8 offset1:12
    ds_read2st64_b32 v[50:51], v22 offset0:8 offset1:12
    s_waitcnt lgkmcnt(5)
    v_max3_f32 v6, v24, v25, v26
    v_max_f32 v6, v6, v27
    v_sub_f32 v24, v24, v6
    v_sub_f32 v25, v25, v6
    v_sub_f32 v26, v26, v6
    v_sub_f32 v27, v27, v6
    v_exp_f32 v24, v24
    v_exp_f32 v25, v25
    v_exp_f32 v26, v26
    v_exp_f32 v27, v27
    s_waitcnt lgkmcnt(4)
    v_mul_f32 v7, v24, v32
    v_fma_f32 v7, v25, v33, v7
    v_fma_f32 v7, v26, v34, v7
    v_fma_f32 v7, v27, v35, v7
    v_rcp_f32 v7, v7
    s_waitcnt lgkmcnt(0)
    v_mul_f32 v12, v24, v40
    v_mul_f32 v13, v24, v48
    v_fma_f32 v12, v25, v41, v12
    v_fma_f32 v13, v25, v49, v13
    v_fma_f32 v12, v26, v42, v12
    v_fma_f32 v13, v26, v50, v13
    v_fma_f32 v12, v27, v43, v12
    v_fma_f32 v13, v27, v51, v13
    v_mul_f32 v12, v12, v7
    v_mul_f32 v13, v13, v7
    v_cvt_pk_bf16_f32 v12, v12, v13
    buffer_store_dword v12, v11, s[40:43], s81 offen nt
L_end:
    s_endpgm
L_sprolog:
    s_setprio 3
    v_mov_b32 v8, s58
    v_mov_b32 v9, s59
    v_and_b32 v11, 2, v1
    v_cmp_ne_u32 vcc, 0, v11
    v_bfe_u32 v11, v1, 2, 2
    v_lshlrev_b32 v11, 3, v11
    v_cndmask_b32 v8, v8, v9, vcc
    v_bfe_u32 v23, v8, v11, 5
    v_and_b32 v11, 1, v1
    v_lshlrev_b32 v11, 8, v11
    v_lshl_add_u32 v11, v23, 13, v11
    v_lshl_add_u32 v36, v20, 6, v11
    s_lshl_b32 s96, s3, 1
    buffer_load_dwordx4 v[24:27], v36, s[28:31], s96 offen offset:0 nt
    buffer_load_dwordx4 v[28:31], v36, s[28:31], s96 offen offset:16 nt
    buffer_load_dwordx4 v[32:35], v36, s[28:31], s96 offen offset:32 nt
    buffer_load_dwordx4 v[36:39], v36, s[28:31], s96 offen offset:48 nt
    s_cmp_eq_u32 s57, 3
    s_cselect_b32 s77, 1, -3
    s_lshl_b32 s77, s77, 16
    s_add_u32 s74, s73, s77
    s_mov_b32 s84, s74
    s_add_u32 s85, s84, 0x4000
    s_add_u32 s86, s84, 0x8000
    s_add_u32 s87, s84, 0xc000
    buffer_load_dwordx4 v[156:159], v2, s[20:23], s84 offen nt
    buffer_load_dwordx4 v[160:163], v2, s[20:23], s85 offen nt
    buffer_load_dwordx4 v[164:167], v2, s[20:23], s86 offen nt
    buffer_load_dwordx4 v[168:171], v2, s[20:23], s87 offen nt
    buffer_load_dwordx4 v[172:175], v3, s[24:27], s84 offen nt
    buffer_load_dwordx4 v[176:179], v3, s[24:27], s85 offen nt
    buffer_load_dwordx4 v[180:183], v3, s[24:27], s86 offen nt
    buffer_load_dwordx4 v[184:187], v3, s[24:27], s87 offen nt
    s_memrealtime s[12:13]
    v_mov_b32 v10, 0
    s_waitcnt lgkmcnt(0)
    s_sub_u32 s11, s12, 400
    s_cmp_lg_u32 s2, 0
    s_cbranch_scc1 L_nonon
    s_or_b32 s13, s13, 0x80000000
    v_mov_b32 v8, s12
    v_mov_b32 v9, s13
    s_mov_b64 exec, 1
    buffer_store_dwordx2 v[8:9], v10, s[48:51], 0 offen sc1
    s_mov_b64 exec, -1
L_nonon:
    s_waitcnt vmcnt(8)
    s_branch L_common
L_shared:
    s_lshl_b32 s82, s55, 3
    s_mov_b32 s83, 0x4030210f
    s_mov_b32 s78, 0x402f200f
    s_bitcmp1_b32 s2, 3
    s_cselect_b32 s83, 0x22104030, s83
    s_cselect_b32 s78, 0x200f402f, s78
    s_bitcmp1_b32 s2, 0
    s_cselect_b32 s83, s78, s83
    s_lshr_b32 s83, s83, s82
    s_and_b32 s83, s83, 0xff
    s_mul_i32 s71, s62, s63
    s_mul_i32 s83, s62, s83
    s_lshr_b32 s71, s71, 6
    s_lshr_b32 s83, s83, 6
    s_mov_b32 s72, s71
    s_bfe_u32 s78, s71, 0x60001
    v_readlane_b32 s79, v4, s78
    s_lshl_b32 s80, s79, 16
    s_and_b32 s79, s79, 0xffff0000
    s_bitcmp1_b32 s71, 0
    s_cselect_b32 s79, s79, s80
    s_add_u32 s79, s79, s3
    s_cmp_lt_u32 s71, s83
    s_cselect_b32 s84, s79, 0xf0000000
    s_add_u32 s71, s71, 1
    s_cmp_lg_u32 s84, s73
    s_cbranch_scc1 L_sredo
    s_bfe_u32 s78, s71, 0x60001
    v_readlane_b32 s79, v4, s78
    s_lshl_b32 s80, s79, 16
    s_and_b32 s79, s79, 0xffff0000
    s_bitcmp1_b32 s71, 0
    s_cselect_b32 s79, s79, s80
    s_add_u32 s79, s79, s3
    s_cmp_lt_u32 s71, s83
    s_cselect_b32 s84, s79, 0xf0000000
    s_add_u32 s71, s71, 1
    s_cmp_lg_u32 s84, s74
    s_cbranch_scc1 L_sredo
L_sgo:
    v_lshlrev_b32 v10, 2, v23
    ds_bpermute_b32 v23, v10, v6
    v_mov_b32 v104, 0
    v_mov_b32 v105, 0
    v_mov_b32 v106, 0
    v_mov_b32 v107, 0
    v_mov_b32 v108, 0
    v_mov_b32 v109, 0
    v_mov_b32 v110, 0
    v_mov_b32 v111, 0
    v_mov_b32 v112, 0
    v_mov_b32 v113, 0
    v_mov_b32 v114, 0
    v_mov_b32 v115, 0
    v_mov_b32 v116, 0
    v_mov_b32 v117, 0
    v_mov_b32 v118, 0
    v_mov_b32 v119, 0
    v_mov_b32 v120, 0
    v_mov_b32 v121, 0
    v_mov_b32 v40, 0
    v_mov_b32 v41, 0
    v_mov_b32 v42, 0
    v_mov_b32 v43, 0
    v_mov_b32 v44, 0
    v_mov_b32 v45, 0
    v_mov_b32 v46, 0
    v_mov_b32 v47, 0
    v_mov_b32 v48, 0
    v_mov_b32 v49, 0
    v_mov_b32 v50, 0
    v_mov_b32 v51, 0
    v_mov_b32 v52, 0
    v_mov_b32 v53, 0
    v_mov_b32 v54, 0
    v_mov_b32 v55, 0
    v_mov_b32 v56, 0
    v_mov_b32 v57, 0
    v_mov_b32 v58, 0
    v_mov_b32 v59, 0
    v_mov_b32 v60, 0
    v_mov_b32 v61, 0
    v_mov_b32 v62, 0
    v_mov_b32 v63, 0
    v_mov_b32 v64, 0
    v_mov_b32 v65, 0
    v_mov_b32 v66, 0
    v_mov_b32 v67, 0
    v_mov_b32 v68, 0
    v_mov_b32 v69, 0
    v_mov_b32 v70, 0
    v_mov_b32 v71, 0
    v_mov_b32 v7, 0
    s_waitcnt lgkmcnt(0)
    v_mov_b32 v6, 0xf149f2ca
    v_mov_b32 v22, 0
    v_lshlrev_b32 v21, 3, v1
    s_lshl_b32 s17, s56, 8
    s_add_u32 s17, s17, 3145728
    s_bfe_u32 s18, s2, 0x10003
    s_lshl2_add_u32 s18, s18, s55
    s_lshl3_add_u32 s18, s18, s17
    s_mov_b32 s16, 0
    s_getreg_b32 s19, hwreg(HW_REG_XCC_ID, 0, 4)
    s_lshl_b32 s19, s19, 24
L_sloop:
    s_cmp_ge_u32 s72, s83
    s_cbranch_scc1 L_sdone
    s_waitcnt vmcnt(12)
    s_cmp_eq_u32 s16, 2
    s_cbranch_scc1 L_hs2
    s_cmp_eq_u32 s16, 0
    s_cbranch_scc1 L_hs00
    v_readfirstlane_b32 s15, v17
    v_readfirstlane_b32 s14, v16
    s_cmp_eq_u32 s15, 0
    s_cbranch_scc1 L_hs0
    s_sub_u32 s77, s14, s11
    s_cmp_ge_u32 s77, 0x100000
    s_cbranch_scc1 L_hs0
    s_xor_b32 s15, s15, s19
    v_mov_b32 v18, s14
    v_mov_b32 v19, s15
    s_mov_b64 exec, 1
    buffer_store_dwordx2 v[18:19], v22, s[44:47], s18 offen offset:128
    s_mov_b64 exec, -1
    s_mov_b32 s16, 2
    s_branch L_hsx
L_hs0:
    buffer_load_dwordx2 v[16:17], v22, s[48:51], 0 offen sc1
    s_branch L_hsx
L_hs00:
    buffer_load_dwordx2 v[16:17], v22, s[48:51], 0 offen sc1
    s_mov_b32 s16, 1
    s_branch L_hsx
L_hs2:
    s_add_u32 s77, s72, 2
    s_cmp_lt_u32 s77, s83
    s_cbranch_scc1 L_hsx
    s_mov_b64 exec, 0xff
    buffer_load_dwordx2 v[18:19], v21, s[44:47], s17 offen offset:128 sc1
    s_mov_b64 exec, -1
    s_mov_b32 s16, 3
L_hsx:
    v_mfma_f32_16x16x32_bf16 v[72:75], v[124:127], v[24:27], 0
    v_mfma_f32_16x16x32_bf16 v[76:79], v[124:127], v[28:31], 0
    v_mfma_f32_16x16x32_bf16 v[80:83], v[124:127], v[32:35], 0
    v_mfma_f32_16x16x32_bf16 v[84:87], v[124:127], v[36:39], 0
    v_mfma_f32_16x16x32_bf16 v[88:91], v[128:131], v[24:27], 0
    v_mfma_f32_16x16x32_bf16 v[92:95], v[128:131], v[28:31], 0
    v_mfma_f32_16x16x32_bf16 v[96:99], v[128:131], v[32:35], 0
    v_mfma_f32_16x16x32_bf16 v[100:103], v[128:131], v[36:39], 0
    s_nop 3
    v_add_f32 v10, v72, v77
    v_add_f32 v11, v82, v87
    v_add_f32 v12, v10, v11
    v_mfma_f32_16x16x32_bf16 v[72:75], v[132:135], v[24:27], 0
    v_mfma_f32_16x16x32_bf16 v[76:79], v[132:135], v[28:31], 0
    v_mfma_f32_16x16x32_bf16 v[80:83], v[132:135], v[32:35], 0
    v_mfma_f32_16x16x32_bf16 v[84:87], v[132:135], v[36:39], 0
    v_add_f32 v10, v88, v93
    v_add_f32 v11, v98, v103
    v_add_f32 v13, v10, v11
    v_mfma_f32_16x16x32_bf16 v[88:91], v[136:139], v[24:27], 0
    v_mfma_f32_16x16x32_bf16 v[92:95], v[136:139], v[28:31], 0
    v_mfma_f32_16x16x32_bf16 v[96:99], v[136:139], v[32:35], 0
    v_mfma_f32_16x16x32_bf16 v[100:103], v[136:139], v[36:39], 0
    s_bfe_u32 s78, s71, 0x60001
    v_readlane_b32 s79, v4, s78
    s_lshl_b32 s80, s79, 16
    s_and_b32 s79, s79, 0xffff0000
    s_bitcmp1_b32 s71, 0
    s_cselect_b32 s79, s79, s80
    s_add_u32 s79, s79, s3
    s_cmp_lt_u32 s71, s83
    s_cselect_b32 s84, s79, 0xf0000000
    s_add_u32 s85, s84, 0x4000
    s_add_u32 s86, s84, 0x8000
    s_add_u32 s87, s84, 0xc000
    s_add_u32 s71, s71, 1
    v_add_f32 v10, v72, v77
    v_add_f32 v11, v82, v87
    v_add_f32 v14, v10, v11
    buffer_load_dwordx4 v[124:127], v2, s[20:23], s84 offen
    buffer_load_dwordx4 v[128:131], v2, s[20:23], s85 offen
    buffer_load_dwordx4 v[132:135], v2, s[20:23], s86 offen
    buffer_load_dwordx4 v[136:139], v2, s[20:23], s87 offen
    v_add_f32 v10, v88, v93
    v_add_f32 v11, v98, v103
    v_add_f32 v15, v10, v11
    v_max3_f32 v10, v12, v13, v14
    v_max_f32 v10, v10, v15
    v_mov_b32 v11, v10
    s_nop 1
    v_permlane32_swap_b32 v10, v11
    s_nop 0
    v_max_f32 v10, v10, v11
    v_mov_b32 v11, v10
    s_nop 1
    v_permlane16_swap_b32 v10, v11
    s_nop 0
    v_max_f32 v10, v10, v11
    v_mul_f32 v10, v23, v10
    v_max_f32 v10, v10, v6
    v_sub_f32 v8, v6, v10
    v_fma_f32 v12, v12, v23, -v10
    v_fma_f32 v13, v13, v23, -v10
    v_fma_f32 v14, v14, v23, -v10
    v_fma_f32 v15, v15, v23, -v10
    v_exp_f32 v8, v8
    v_exp_f32 v12, v12
    v_exp_f32 v13, v13
    v_exp_f32 v14, v14
    v_exp_f32 v15, v15
    v_mov_b32 v6, v10
    v_add_f32 v10, v12, v13
    v_fma_f32 v7, v7, v8, v10
    v_add_f32 v10, v14, v15
    v_add_f32 v7, v7, v10
    v_pk_mul_f32 v[40:41], v[40:41], v[8:9] op_sel_hi:[1,0]
    v_pk_mul_f32 v[42:43], v[42:43], v[8:9] op_sel_hi:[1,0]
    v_pk_mul_f32 v[44:45], v[44:45], v[8:9] op_sel_hi:[1,0]
    v_pk_mul_f32 v[46:47], v[46:47], v[8:9] op_sel_hi:[1,0]
    v_pk_mul_f32 v[48:49], v[48:49], v[8:9] op_sel_hi:[1,0]
    v_pk_mul_f32 v[50:51], v[50:51], v[8:9] op_sel_hi:[1,0]
    v_pk_mul_f32 v[52:53], v[52:53], v[8:9] op_sel_hi:[1,0]
    v_pk_mul_f32 v[54:55], v[54:55], v[8:9] op_sel_hi:[1,0]
    v_pk_mul_f32 v[56:57], v[56:57], v[8:9] op_sel_hi:[1,0]
    v_pk_mul_f32 v[58:59], v[58:59], v[8:9] op_sel_hi:[1,0]
    v_pk_mul_f32 v[60:61], v[60:61], v[8:9] op_sel_hi:[1,0]
    v_pk_mul_f32 v[62:63], v[62:63], v[8:9] op_sel_hi:[1,0]
    v_pk_mul_f32 v[64:65], v[64:65], v[8:9] op_sel_hi:[1,0]
    v_pk_mul_f32 v[66:67], v[66:67], v[8:9] op_sel_hi:[1,0]
    v_pk_mul_f32 v[68:69], v[68:69], v[8:9] op_sel_hi:[1,0]
    v_pk_mul_f32 v[70:71], v[70:71], v[8:9] op_sel_hi:[1,0]
    s_add_u32 s72, s72, 1
    v_cvt_pk_bf16_f32 v106, v12, 0
    v_cvt_pk_bf16_f32 v111, v12, 0
    v_cvt_pk_bf16_f32 v114, 0, v12
    v_cvt_pk_bf16_f32 v119, 0, v12
    s_waitcnt vmcnt(12)
    s_nop 1
    v_mfma_f32_16x16x32_bf16 v[40:43], v[140:143], v[106:109], v[40:43]
    v_mfma_f32_16x16x32_bf16 v[56:59], v[140:143], v[104:107], v[56:59]
    v_mfma_f32_16x16x32_bf16 v[48:51], v[140:143], v[110:113], v[48:51]
    v_mfma_f32_16x16x32_bf16 v[64:67], v[140:143], v[108:111], v[64:67]
    v_mfma_f32_16x16x32_bf16 v[44:47], v[140:143], v[114:117], v[44:47]
    v_mfma_f32_16x16x32_bf16 v[60:63], v[140:143], v[112:115], v[60:63]
    v_mfma_f32_16x16x32_bf16 v[52:55], v[140:143], v[118:121], v[52:55]
    v_mfma_f32_16x16x32_bf16 v[68:71], v[140:143], v[116:119], v[68:71]
    v_cvt_pk_bf16_f32 v106, v13, 0
    v_cvt_pk_bf16_f32 v111, v13, 0
    v_cvt_pk_bf16_f32 v114, 0, v13
    v_cvt_pk_bf16_f32 v119, 0, v13
    s_nop 1
    v_mfma_f32_16x16x32_bf16 v[40:43], v[144:147], v[106:109], v[40:43]
    v_mfma_f32_16x16x32_bf16 v[56:59], v[144:147], v[104:107], v[56:59]
    v_mfma_f32_16x16x32_bf16 v[48:51], v[144:147], v[110:113], v[48:51]
    v_mfma_f32_16x16x32_bf16 v[64:67], v[144:147], v[108:111], v[64:67]
    v_mfma_f32_16x16x32_bf16 v[44:47], v[144:147], v[114:117], v[44:47]
    v_mfma_f32_16x16x32_bf16 v[60:63], v[144:147], v[112:115], v[60:63]
    v_mfma_f32_16x16x32_bf16 v[52:55], v[144:147], v[118:121], v[52:55]
    v_mfma_f32_16x16x32_bf16 v[68:71], v[144:147], v[116:119], v[68:71]
    v_cvt_pk_bf16_f32 v106, v14, 0
    v_cvt_pk_bf16_f32 v111, v14, 0
    v_cvt_pk_bf16_f32 v114, 0, v14
    v_cvt_pk_bf16_f32 v119, 0, v14
    s_nop 1
    v_mfma_f32_16x16x32_bf16 v[40:43], v[148:151], v[106:109], v[40:43]
    v_mfma_f32_16x16x32_bf16 v[56:59], v[148:151], v[104:107], v[56:59]
    v_mfma_f32_16x16x32_bf16 v[48:51], v[148:151], v[110:113], v[48:51]
    v_mfma_f32_16x16x32_bf16 v[64:67], v[148:151], v[108:111], v[64:67]
    v_mfma_f32_16x16x32_bf16 v[44:47], v[148:151], v[114:117], v[44:47]
    v_mfma_f32_16x16x32_bf16 v[60:63], v[148:151], v[112:115], v[60:63]
    v_mfma_f32_16x16x32_bf16 v[52:55], v[148:151], v[118:121], v[52:55]
    v_mfma_f32_16x16x32_bf16 v[68:71], v[148:151], v[116:119], v[68:71]
    v_cvt_pk_bf16_f32 v106, v15, 0
    v_cvt_pk_bf16_f32 v111, v15, 0
    v_cvt_pk_bf16_f32 v114, 0, v15
    v_cvt_pk_bf16_f32 v119, 0, v15
    s_nop 1
    v_mfma_f32_16x16x32_bf16 v[40:43], v[152:155], v[106:109], v[40:43]
    v_mfma_f32_16x16x32_bf16 v[56:59], v[152:155], v[104:107], v[56:59]
    v_mfma_f32_16x16x32_bf16 v[48:51], v[152:155], v[110:113], v[48:51]
    v_mfma_f32_16x16x32_bf16 v[64:67], v[152:155], v[108:111], v[64:67]
    v_mfma_f32_16x16x32_bf16 v[44:47], v[152:155], v[114:117], v[44:47]
    v_mfma_f32_16x16x32_bf16 v[60:63], v[152:155], v[112:115], v[60:63]
    v_mfma_f32_16x16x32_bf16 v[52:55], v[152:155], v[118:121], v[52:55]
    v_mfma_f32_16x16x32_bf16 v[68:71], v[152:155], v[116:119], v[68:71]
    buffer_load_dwordx4 v[140:143], v3, s[24:27], s84 offen
    buffer_load_dwordx4 v[144:147], v3, s[24:27], s85 offen
    buffer_load_dwordx4 v[148:151], v3, s[24:27], s86 offen
    buffer_load_dwordx4 v[152:155], v3, s[24:27], s87 offen
    s_cmp_ge_u32 s72, s83
    s_cbranch_scc1 L_sdone
    s_waitcnt vmcnt(12)
    v_mfma_f32_16x16x32_bf16 v[72:75], v[156:159], v[24:27], 0
    v_mfma_f32_16x16x32_bf16 v[76:79], v[156:159], v[28:31], 0
    v_mfma_f32_16x16x32_bf16 v[80:83], v[156:159], v[32:35], 0
    v_mfma_f32_16x16x32_bf16 v[84:87], v[156:159], v[36:39], 0
    v_mfma_f32_16x16x32_bf16 v[88:91], v[160:163], v[24:27], 0
    v_mfma_f32_16x16x32_bf16 v[92:95], v[160:163], v[28:31], 0
    v_mfma_f32_16x16x32_bf16 v[96:99], v[160:163], v[32:35], 0
    v_mfma_f32_16x16x32_bf16 v[100:103], v[160:163], v[36:39], 0
    s_nop 3
    v_add_f32 v10, v72, v77
    v_add_f32 v11, v82, v87
    v_add_f32 v12, v10, v11
    v_mfma_f32_16x16x32_bf16 v[72:75], v[164:167], v[24:27], 0
    v_mfma_f32_16x16x32_bf16 v[76:79], v[164:167], v[28:31], 0
    v_mfma_f32_16x16x32_bf16 v[80:83], v[164:167], v[32:35], 0
    v_mfma_f32_16x16x32_bf16 v[84:87], v[164:167], v[36:39], 0
    v_add_f32 v10, v88, v93
    v_add_f32 v11, v98, v103
    v_add_f32 v13, v10, v11
    v_mfma_f32_16x16x32_bf16 v[88:91], v[168:171], v[24:27], 0
    v_mfma_f32_16x16x32_bf16 v[92:95], v[168:171], v[28:31], 0
    v_mfma_f32_16x16x32_bf16 v[96:99], v[168:171], v[32:35], 0
    v_mfma_f32_16x16x32_bf16 v[100:103], v[168:171], v[36:39], 0
    s_bfe_u32 s78, s71, 0x60001
    v_readlane_b32 s79, v4, s78
    s_lshl_b32 s80, s79, 16
    s_and_b32 s79, s79, 0xffff0000
    s_bitcmp1_b32 s71, 0
    s_cselect_b32 s79, s79, s80
    s_add_u32 s79, s79, s3
    s_cmp_lt_u32 s71, s83
    s_cselect_b32 s84, s79, 0xf0000000
    s_add_u32 s85, s84, 0x4000
    s_add_u32 s86, s84, 0x8000
    s_add_u32 s87, s84, 0xc000
    s_add_u32 s71, s71, 1
    v_add_f32 v10, v72, v77
    v_add_f32 v11, v82, v87
    v_add_f32 v14, v10, v11
    buffer_load_dwordx4 v[156:159], v2, s[20:23], s84 offen
    buffer_load_dwordx4 v[160:163], v2, s[20:23], s85 offen
    buffer_load_dwordx4 v[164:167], v2, s[20:23], s86 offen
    buffer_load_dwordx4 v[168:171], v2, s[20:23], s87 offen
    v_add_f32 v10, v88, v93
    v_add_f32 v11, v98, v103
    v_add_f32 v15, v10, v11
    v_max3_f32 v10, v12, v13, v14
    v_max_f32 v10, v10, v15
    v_mov_b32 v11, v10
    s_nop 1
    v_permlane32_swap_b32 v10, v11
    s_nop 0
    v_max_f32 v10, v10, v11
    v_mov_b32 v11, v10
    s_nop 1
    v_permlane16_swap_b32 v10, v11
    s_nop 0
    v_max_f32 v10, v10, v11
    v_mul_f32 v10, v23, v10
    v_max_f32 v10, v10, v6
    v_sub_f32 v8, v6, v10
    v_fma_f32 v12, v12, v23, -v10
    v_fma_f32 v13, v13, v23, -v10
    v_fma_f32 v14, v14, v23, -v10
    v_fma_f32 v15, v15, v23, -v10
    v_exp_f32 v8, v8
    v_exp_f32 v12, v12
    v_exp_f32 v13, v13
    v_exp_f32 v14, v14
    v_exp_f32 v15, v15
    v_mov_b32 v6, v10
    v_add_f32 v10, v12, v13
    v_fma_f32 v7, v7, v8, v10
    v_add_f32 v10, v14, v15
    v_add_f32 v7, v7, v10
    v_pk_mul_f32 v[40:41], v[40:41], v[8:9] op_sel_hi:[1,0]
    v_pk_mul_f32 v[42:43], v[42:43], v[8:9] op_sel_hi:[1,0]
    v_pk_mul_f32 v[44:45], v[44:45], v[8:9] op_sel_hi:[1,0]
    v_pk_mul_f32 v[46:47], v[46:47], v[8:9] op_sel_hi:[1,0]
    v_pk_mul_f32 v[48:49], v[48:49], v[8:9] op_sel_hi:[1,0]
    v_pk_mul_f32 v[50:51], v[50:51], v[8:9] op_sel_hi:[1,0]
    v_pk_mul_f32 v[52:53], v[52:53], v[8:9] op_sel_hi:[1,0]
    v_pk_mul_f32 v[54:55], v[54:55], v[8:9] op_sel_hi:[1,0]
    v_pk_mul_f32 v[56:57], v[56:57], v[8:9] op_sel_hi:[1,0]
    v_pk_mul_f32 v[58:59], v[58:59], v[8:9] op_sel_hi:[1,0]
    v_pk_mul_f32 v[60:61], v[60:61], v[8:9] op_sel_hi:[1,0]
    v_pk_mul_f32 v[62:63], v[62:63], v[8:9] op_sel_hi:[1,0]
    v_pk_mul_f32 v[64:65], v[64:65], v[8:9] op_sel_hi:[1,0]
    v_pk_mul_f32 v[66:67], v[66:67], v[8:9] op_sel_hi:[1,0]
    v_pk_mul_f32 v[68:69], v[68:69], v[8:9] op_sel_hi:[1,0]
    v_pk_mul_f32 v[70:71], v[70:71], v[8:9] op_sel_hi:[1,0]
    s_add_u32 s72, s72, 1
    v_cvt_pk_bf16_f32 v106, v12, 0
    v_cvt_pk_bf16_f32 v111, v12, 0
    v_cvt_pk_bf16_f32 v114, 0, v12
    v_cvt_pk_bf16_f32 v119, 0, v12
    s_waitcnt vmcnt(12)
    s_nop 1
    v_mfma_f32_16x16x32_bf16 v[40:43], v[172:175], v[106:109], v[40:43]
    v_mfma_f32_16x16x32_bf16 v[56:59], v[172:175], v[104:107], v[56:59]
    v_mfma_f32_16x16x32_bf16 v[48:51], v[172:175], v[110:113], v[48:51]
    v_mfma_f32_16x16x32_bf16 v[64:67], v[172:175], v[108:111], v[64:67]
    v_mfma_f32_16x16x32_bf16 v[44:47], v[172:175], v[114:117], v[44:47]
    v_mfma_f32_16x16x32_bf16 v[60:63], v[172:175], v[112:115], v[60:63]
    v_mfma_f32_16x16x32_bf16 v[52:55], v[172:175], v[118:121], v[52:55]
    v_mfma_f32_16x16x32_bf16 v[68:71], v[172:175], v[116:119], v[68:71]
    v_cvt_pk_bf16_f32 v106, v13, 0
    v_cvt_pk_bf16_f32 v111, v13, 0
    v_cvt_pk_bf16_f32 v114, 0, v13
    v_cvt_pk_bf16_f32 v119, 0, v13
    s_nop 1
    v_mfma_f32_16x16x32_bf16 v[40:43], v[176:179], v[106:109], v[40:43]
    v_mfma_f32_16x16x32_bf16 v[56:59], v[176:179], v[104:107], v[56:59]
    v_mfma_f32_16x16x32_bf16 v[48:51], v[176:179], v[110:113], v[48:51]
    v_mfma_f32_16x16x32_bf16 v[64:67], v[176:179], v[108:111], v[64:67]
    v_mfma_f32_16x16x32_bf16 v[44:47], v[176:179], v[114:117], v[44:47]
    v_mfma_f32_16x16x32_bf16 v[60:63], v[176:179], v[112:115], v[60:63]
    v_mfma_f32_16x16x32_bf16 v[52:55], v[176:179], v[118:121], v[52:55]
    v_mfma_f32_16x16x32_bf16 v[68:71], v[176:179], v[116:119], v[68:71]
    v_cvt_pk_bf16_f32 v106, v14, 0
    v_cvt_pk_bf16_f32 v111, v14, 0
    v_cvt_pk_bf16_f32 v114, 0, v14
    v_cvt_pk_bf16_f32 v119, 0, v14
    s_nop 1
    v_mfma_f32_16x16x32_bf16 v[40:43], v[180:183], v[106:109], v[40:43]
    v_mfma_f32_16x16x32_bf16 v[56:59], v[180:183], v[104:107], v[56:59]
    v_mfma_f32_16x16x32_bf16 v[48:51], v[180:183], v[110:113], v[48:51]
    v_mfma_f32_16x16x32_bf16 v[64:67], v[180:183], v[108:111], v[64:67]
    v_mfma_f32_16x16x32_bf16 v[44:47], v[180:183], v[114:117], v[44:47]
    v_mfma_f32_16x16x32_bf16 v[60:63], v[180:183], v[112:115], v[60:63]
    v_mfma_f32_16x16x32_bf16 v[52:55], v[180:183], v[118:121], v[52:55]
    v_mfma_f32_16x16x32_bf16 v[68:71], v[180:183], v[116:119], v[68:71]
    v_cvt_pk_bf16_f32 v106, v15, 0
    v_cvt_pk_bf16_f32 v111, v15, 0
    v_cvt_pk_bf16_f32 v114, 0, v15
    v_cvt_pk_bf16_f32 v119, 0, v15
    s_nop 1
    v_mfma_f32_16x16x32_bf16 v[40:43], v[184:187], v[106:109], v[40:43]
    v_mfma_f32_16x16x32_bf16 v[56:59], v[184:187], v[104:107], v[56:59]
    v_mfma_f32_16x16x32_bf16 v[48:51], v[184:187], v[110:113], v[48:51]
    v_mfma_f32_16x16x32_bf16 v[64:67], v[184:187], v[108:111], v[64:67]
    v_mfma_f32_16x16x32_bf16 v[44:47], v[184:187], v[114:117], v[44:47]
    v_mfma_f32_16x16x32_bf16 v[60:63], v[184:187], v[112:115], v[60:63]
    v_mfma_f32_16x16x32_bf16 v[52:55], v[184:187], v[118:121], v[52:55]
    v_mfma_f32_16x16x32_bf16 v[68:71], v[184:187], v[116:119], v[68:71]
    buffer_load_dwordx4 v[172:175], v3, s[24:27], s84 offen
    buffer_load_dwordx4 v[176:179], v3, s[24:27], s85 offen
    buffer_load_dwordx4 v[180:183], v3, s[24:27], s86 offen
    buffer_load_dwordx4 v[184:187], v3, s[24:27], s87 offen
    s_branch L_sloop
L_sdone:
    s_cmp_ge_u32 s16, 2
    s_cbranch_scc1 L_havetag
    buffer_load_dwordx2 v[16:17], v22, s[48:51], 0 offen sc1
L_havetag:
    v_mov_b32 v11, v7
    s_nop 1
    v_permlane32_swap_b32 v7, v11
    s_nop 0
    v_add_f32 v7, v7, v11
    v_mov_b32 v11, v7
    s_nop 1
    v_permlane16_swap_b32 v7, v11
    s_nop 0
    v_add_f32 v7, v7, v11
    v_and_b32 v11, 2, v1
    v_cmp_ne_u32 vcc, 0, v11
    v_bfe_u32 v10, v1, 2, 2
    v_mul_u32_u24 v12, 8192, v10
    v_and_b32 v11, 3, v1
    v_lshl_add_u32 v12, v11, 4, v12
    v_lshl_add_u32 v12, v20, 6, v12
    s_mul_i32 s77, s56, 32768
    s_mul_i32 s78, s55, 512
    s_add_u32 s78, s78, s77
    s_mov_b32 s79, 4096
    s_mov_b32 s80, 2048
    s_bitcmp1_b32 s2, 3
    s_cselect_b32 s79, 0, s79
    s_cselect_b32 s80, 6144, s80
    s_add_u32 s84, s78, s79
    s_add_u32 s85, s78, s80
    v_mov_b32_dpp v72, v40 quad_perm:[2,3,0,1] row_mask:0xf bank_mask:0xf
    v_mov_b32_dpp v76, v44 quad_perm:[2,3,0,1] row_mask:0xf bank_mask:0xf
    v_mov_b32_dpp v73, v41 quad_perm:[2,3,0,1] row_mask:0xf bank_mask:0xf
    v_mov_b32_dpp v77, v45 quad_perm:[2,3,0,1] row_mask:0xf bank_mask:0xf
    v_mov_b32_dpp v74, v42 quad_perm:[2,3,0,1] row_mask:0xf bank_mask:0xf
    v_mov_b32_dpp v78, v46 quad_perm:[2,3,0,1] row_mask:0xf bank_mask:0xf
    v_mov_b32_dpp v75, v43 quad_perm:[2,3,0,1] row_mask:0xf bank_mask:0xf
    v_mov_b32_dpp v79, v47 quad_perm:[2,3,0,1] row_mask:0xf bank_mask:0xf
    v_cndmask_b32 v40, v40, v76, vcc
    v_cndmask_b32 v44, v72, v44, vcc
    v_cndmask_b32 v41, v41, v77, vcc
    v_cndmask_b32 v45, v73, v45, vcc
    v_cndmask_b32 v42, v42, v78, vcc
    v_cndmask_b32 v46, v74, v46, vcc
    v_cndmask_b32 v43, v43, v79, vcc
    v_cndmask_b32 v47, v75, v47, vcc
    v_mov_b32_dpp v72, v48 quad_perm:[2,3,0,1] row_mask:0xf bank_mask:0xf
    v_mov_b32_dpp v76, v52 quad_perm:[2,3,0,1] row_mask:0xf bank_mask:0xf
    v_mov_b32_dpp v73, v49 quad_perm:[2,3,0,1] row_mask:0xf bank_mask:0xf
    v_mov_b32_dpp v77, v53 quad_perm:[2,3,0,1] row_mask:0xf bank_mask:0xf
    v_mov_b32_dpp v74, v50 quad_perm:[2,3,0,1] row_mask:0xf bank_mask:0xf
    v_mov_b32_dpp v78, v54 quad_perm:[2,3,0,1] row_mask:0xf bank_mask:0xf
    v_mov_b32_dpp v75, v51 quad_perm:[2,3,0,1] row_mask:0xf bank_mask:0xf
    v_mov_b32_dpp v79, v55 quad_perm:[2,3,0,1] row_mask:0xf bank_mask:0xf
    v_cndmask_b32 v48, v48, v76, vcc
    v_cndmask_b32 v52, v72, v52, vcc
    v_cndmask_b32 v49, v49, v77, vcc
    v_cndmask_b32 v53, v73, v53, vcc
    v_cndmask_b32 v50, v50, v78, vcc
    v_cndmask_b32 v54, v74, v54, vcc
    v_cndmask_b32 v51, v51, v79, vcc
    v_cndmask_b32 v55, v75, v55, vcc
    v_mov_b32_dpp v72, v56 quad_perm:[2,3,0,1] row_mask:0xf bank_mask:0xf
    v_mov_b32_dpp v76, v60 quad_perm:[2,3,0,1] row_mask:0xf bank_mask:0xf
    v_mov_b32_dpp v73, v57 quad_perm:[2,3,0,1] row_mask:0xf bank_mask:0xf
    v_mov_b32_dpp v77, v61 quad_perm:[2,3,0,1] row_mask:0xf bank_mask:0xf
    v_mov_b32_dpp v74, v58 quad_perm:[2,3,0,1] row_mask:0xf bank_mask:0xf
    v_mov_b32_dpp v78, v62 quad_perm:[2,3,0,1] row_mask:0xf bank_mask:0xf
    v_mov_b32_dpp v75, v59 quad_perm:[2,3,0,1] row_mask:0xf bank_mask:0xf
    v_mov_b32_dpp v79, v63 quad_perm:[2,3,0,1] row_mask:0xf bank_mask:0xf
    v_cndmask_b32 v56, v56, v76, vcc
    v_cndmask_b32 v60, v72, v60, vcc
    v_cndmask_b32 v57, v57, v77, vcc
    v_cndmask_b32 v61, v73, v61, vcc
    v_cndmask_b32 v58, v58, v78, vcc
    v_cndmask_b32 v62, v74, v62, vcc
    v_cndmask_b32 v59, v59, v79, vcc
    v_cndmask_b32 v63, v75, v63, vcc
    v_mov_b32_dpp v72, v64 quad_perm:[2,3,0,1] row_mask:0xf bank_mask:0xf
    v_mov_b32_dpp v76, v68 quad_perm:[2,3,0,1] row_mask:0xf bank_mask:0xf
    v_mov_b32_dpp v73, v65 quad_perm:[2,3,0,1] row_mask:0xf bank_mask:0xf
    v_mov_b32_dpp v77, v69 quad_perm:[2,3,0,1] row_mask:0xf bank_mask:0xf
    v_mov_b32_dpp v74, v66 quad_perm:[2,3,0,1] row_mask:0xf bank_mask:0xf
    v_mov_b32_dpp v78, v70 quad_perm:[2,3,0,1] row_mask:0xf bank_mask:0xf
    v_mov_b32_dpp v75, v67 quad_perm:[2,3,0,1] row_mask:0xf bank_mask:0xf
    v_mov_b32_dpp v79, v71 quad_perm:[2,3,0,1] row_mask:0xf bank_mask:0xf
    v_cndmask_b32 v64, v64, v76, vcc
    v_cndmask_b32 v68, v72, v68, vcc
    v_cndmask_b32 v65, v65, v77, vcc
    v_cndmask_b32 v69, v73, v69, vcc
    v_cndmask_b32 v66, v66, v78, vcc
    v_cndmask_b32 v70, v74, v70, vcc
    v_cndmask_b32 v67, v67, v79, vcc
    v_cndmask_b32 v71, v75, v71, vcc
    v_cvt_pk_bf16_f32 v72, v40, v41
    v_cvt_pk_bf16_f32 v73, v42, v43
    v_cvt_pk_bf16_f32 v74, v48, v49
    v_cvt_pk_bf16_f32 v75, v50, v51
    v_cvt_pk_bf16_f32 v76, v56, v57
    v_cvt_pk_bf16_f32 v77, v58, v59
    v_cvt_pk_bf16_f32 v78, v64, v65
    v_cvt_pk_bf16_f32 v79, v66, v67
    v_cvt_pk_bf16_f32 v80, v44, v45
    v_cvt_pk_bf16_f32 v81, v46, v47
    v_cvt_pk_bf16_f32 v82, v52, v53
    v_cvt_pk_bf16_f32 v83, v54, v55
    v_cvt_pk_bf16_f32 v84, v60, v61
    v_cvt_pk_bf16_f32 v85, v62, v63
    v_cvt_pk_bf16_f32 v86, v68, v69
    v_cvt_pk_bf16_f32 v87, v70, v71
    s_sub_u32 s86, s18, s17
    s_lshl_b32 s86, s86, 4
    s_lshl_b32 s81, s56, 10
    s_add_u32 s81, s81, 2097152
    s_add_u32 s86, s86, s81
    s_cmp_lg_u32 s16, 3
    s_cbranch_scc1 L_putfar
    s_waitcnt vmcnt(8)
    s_mov_b64 exec, 0xff
    v_cmp_ne_u64 vcc, s[14:15], v[18:19]
    s_mov_b64 exec, -1
    s_cmp_eq_u64 vcc, 0
    s_cbranch_scc1 L_putnear
    s_mov_b64 exec, 0xff
    buffer_load_dwordx2 v[18:19], v21, s[44:47], s17 offen offset:128 sc1
    s_waitcnt vmcnt(0)
    v_cmp_ne_u64 vcc, s[14:15], v[18:19]
    s_mov_b64 exec, -1
    s_cmp_lg_u64 vcc, 0
    s_cbranch_scc1 L_putfar
L_putnear:
    buffer_store_dwordx4 v[72:75], v12, s[44:47], s84 offen offset:0
    buffer_store_dwordx4 v[76:79], v12, s[44:47], s84 offen offset:256
    buffer_store_dwordx4 v[80:83], v12, s[44:47], s85 offen offset:0
    buffer_store_dwordx4 v[84:87], v12, s[44:47], s85 offen offset:256
    s_mov_b64 exec, 0xffff
    buffer_store_dwordx2 v[6:7], v21, s[44:47], s86 offen
    s_mov_b64 exec, -1
    s_mov_b32 s16, 4
    s_branch L_putx
L_putfar:
    buffer_store_dwordx4 v[72:75], v12, s[44:47], s84 offen offset:0 sc1
    buffer_store_dwordx4 v[76:79], v12, s[44:47], s84 offen offset:256 sc1
    buffer_store_dwordx4 v[80:83], v12, s[44:47], s85 offen offset:0 sc1
    buffer_store_dwordx4 v[84:87], v12, s[44:47], s85 offen offset:256 sc1
    s_mov_b64 exec, 0xffff
    buffer_store_dwordx2 v[6:7], v21, s[44:47], s86 offen sc1
    s_mov_b64 exec, -1
L_putx:
    s_mov_b32 s82, 0
L_nwait:
    s_waitcnt vmcnt(0)
    v_readfirstlane_b32 s13, v17
    v_readfirstlane_b32 s12, v16
    s_add_u32 s82, s82, 1
    s_cmp_eq_u32 s13, 0
    s_cbranch_scc1 L_nagain
    s_sub_u32 s12, s12, s11
    s_cmp_lt_u32 s12, 0x100000
    s_cbranch_scc1 L_nok
    s_cmp_gt_u32 s82, 48
    s_cbranch_scc1 L_nok
L_nagain:
    s_sleep 4
    buffer_load_dwordx2 v[16:17], v22, s[48:51], 0 offen sc1
    s_cmp_lt_u32 s82, 0x80000
    s_cbranch_scc1 L_nwait
L_nok:
    s_mov_b64 exec, 1
    s_cmp_lg_u32 s16, 4
    s_cbranch_scc1 L_flagfar
    buffer_store_dwordx2 v[16:17], v22, s[44:47], s18 offen
    s_branch L_flagx
L_flagfar:
    buffer_store_dwordx2 v[16:17], v22, s[44:47], s18 offen sc1
L_flagx:
    s_mov_b64 exec, 0xff
L_poll:
    buffer_load_dwordx2 v[72:73], v21, s[44:47], s17 offen sc1
    s_add_u32 s82, s82, 1
    s_waitcnt vmcnt(0)
    v_cmp_ne_u64 vcc, v[72:73], v[16:17]
    s_nop 1
    s_cmp_eq_u64 vcc, 0
    s_cbranch_scc1 L_polled
    s_sleep 4
    s_cmp_lt_u32 s82, 0x80000
    s_cbranch_scc1 L_poll
L_polled:
    s_mov_b64 exec, -1
    s_mul_i32 s78, s55, 8192
    s_add_u32 s78, s78, s77
    s_bfe_u32 s79, s2, 0x10003
    s_mul_i32 s79, s79, 4096
    s_add_u32 s78, s78, s79
    v_bfe_u32 v10, v1, 1, 1
    v_lshlrev_b32 v13, 3, v10
    s_lshl_b32 s79, s55, 5
    s_add_u32 s81, s81, s79
    s_add_u32 s82, s81, 512
    s_bitcmp1_b32 s2, 3
    s_cselect_b32 s84, s81, s82
    s_cselect_b32 s85, s82, s81
    buffer_load_dwordx2 v[72:73], v13, s[44:47], s84 offen offset:0 sc1
    buffer_load_dwordx2 v[74:75], v13, s[44:47], s84 offen offset:128 sc1
    buffer_load_dwordx2 v[76:77], v13, s[44:47], s84 offen offset:256 sc1
    buffer_load_dwordx2 v[78:79], v13, s[44:47], s84 offen offset:384 sc1
    buffer_load_dwordx2 v[80:81], v13, s[44:47], s85 offen offset:16 sc1
    buffer_load_dwordx2 v[82:83], v13, s[44:47], s85 offen offset:144 sc1
    buffer_load_dwordx2 v[84:85], v13, s[44:47], s85 offen offset:272 sc1
    buffer_load_dwordx2 v[86:87], v13, s[44:47], s85 offen offset:400 sc1
    buffer_load_dwordx2 v[104:105], v21, s[44:47], s78 offen offset:0 sc1
    buffer_load_dwordx2 v[106:107], v21, s[44:47], s78 offen offset:512 sc1
    buffer_load_dwordx2 v[108:109], v21, s[44:47], s78 offen offset:1024 sc1
    buffer_load_dwordx2 v[110:111], v21, s[44:47], s78 offen offset:1536 sc1
    buffer_load_dwordx2 v[112:113], v21, s[44:47], s78 offen offset:2048 sc1
    buffer_load_dwordx2 v[114:115], v21, s[44:47], s78 offen offset:2560 sc1
    buffer_load_dwordx2 v[116:117], v21, s[44:47], s78 offen offset:3072 sc1
    buffer_load_dwordx2 v[118:119], v21, s[44:47], s78 offen offset:3584 sc1
L_getx:
    v_lshlrev_b32 v14, 7, v10
    v_lshrrev_b32 v11, 5, v1
    v_lshl_add_u32 v14, v11, 6, v14
    v_and_b32 v11, 1, v1
    v_lshl_add_u32 v14, v11, 5, v14
    v_bfe_u32 v11, v1, 2, 1
    v_lshl_add_u32 v14, v11, 4, v14
    v_bfe_u32 v11, v1, 3, 2
    v_lshl_add_u32 v14, v11, 8, v14
    v_mul_u32_u24 v22, 32, v10
    s_waitcnt vmcnt(8)
    v_max3_f32 v96, v72, v74, v76
    v_max_f32 v96, v96, v78
    v_max3_f32 v97, v80, v82, v84
    v_max_f32 v97, v97, v86
    v_sub_f32 v88, v72, v96
    v_sub_f32 v89, v74, v96
    v_sub_f32 v90, v76, v96
    v_sub_f32 v91, v78, v96
    v_sub_f32 v92, v80, v97
    v_sub_f32 v93, v82, v97
    v_sub_f32 v94, v84, v97
    v_sub_f32 v95, v86, v97
    v_exp_f32 v88, v88
    v_exp_f32 v89, v89
    v_exp_f32 v90, v90
    v_exp_f32 v91, v91
    v_exp_f32 v92, v92
    v_exp_f32 v93, v93
    v_exp_f32 v94, v94
    v_exp_f32 v95, v95
    v_mul_f32 v98, v88, v73
    v_fma_f32 v98, v89, v75, v98
    v_fma_f32 v98, v90, v77, v98
    v_fma_f32 v98, v91, v79, v98
    v_mul_f32 v99, v92, v81
    v_fma_f32 v99, v93, v83, v99
    v_fma_f32 v99, v94, v85, v99
    v_fma_f32 v99, v95, v87, v99
    s_waitcnt vmcnt(0)
    v_lshlrev_b32 v40, 16, v104
    v_and_b32 v41, 0xffff0000, v104
    v_lshlrev_b32 v42, 16, v105
    v_and_b32 v43, 0xffff0000, v105
    v_lshlrev_b32 v44, 16, v106
    v_and_b32 v45, 0xffff0000, v106
    v_lshlrev_b32 v46, 16, v107
    v_and_b32 v47, 0xffff0000, v107
    v_lshlrev_b32 v48, 16, v108
    v_and_b32 v49, 0xffff0000, v108
    v_lshlrev_b32 v50, 16, v109
    v_and_b32 v51, 0xffff0000, v109
    v_lshlrev_b32 v52, 16, v110
    v_and_b32 v53, 0xffff0000, v110
    v_lshlrev_b32 v54, 16, v111
    v_and_b32 v55, 0xffff0000, v111
    v_lshlrev_b32 v56, 16, v112
    v_and_b32 v57, 0xffff0000, v112
    v_lshlrev_b32 v58, 16, v113
    v_and_b32 v59, 0xffff0000, v113
    v_lshlrev_b32 v60, 16, v114
    v_and_b32 v61, 0xffff0000, v114
    v_lshlrev_b32 v62, 16, v115
    v_and_b32 v63, 0xffff0000, v115
    v_lshlrev_b32 v64, 16, v116
    v_and_b32 v65, 0xffff0000, v116
    v_lshlrev_b32 v66, 16, v117
    v_and_b32 v67, 0xffff0000, v117
    v_lshlrev_b32 v68, 16, v118
    v_and_b32 v69, 0xffff0000, v118
    v_lshlrev_b32 v70, 16, v119
    v_and_b32 v71, 0xffff0000, v119
    v_mul_f32 v40, v88, v40
    v_mul_f32 v41, v88, v41
    v_mul_f32 v42, v88, v42
    v_mul_f32 v43, v88, v43
    v_fma_f32 v40, v89, v44, v40
    v_fma_f32 v41, v89, v45, v41
    v_fma_f32 v42, v89, v46, v42
    v_fma_f32 v43, v89, v47, v43
    v_fma_f32 v40, v90, v48, v40
    v_fma_f32 v41, v90, v49, v41
    v_fma_f32 v42, v90, v50, v42
    v_fma_f32 v43, v90, v51, v43
    v_fma_f32 v40, v91, v52, v40
    v_fma_f32 v41, v91, v53, v41
    v_fma_f32 v42, v91, v54, v42
    v_fma_f32 v43, v91, v55, v43
    ds_write_b128 v14, v[40:43] offset:3072
    ds_write_b32 v22, v96 offset:8204
    ds_write_b32 v22, v98 offset:8220
    v_mul_f32 v56, v92, v56
    v_mul_f32 v57, v92, v57
    v_mul_f32 v58, v92, v58
    v_mul_f32 v59, v92, v59
    v_fma_f32 v56, v93, v60, v56
    v_fma_f32 v57, v93, v61, v57
    v_fma_f32 v58, v93, v62, v58
    v_fma_f32 v59, v93, v63, v59
    v_fma_f32 v56, v94, v64, v56
    v_fma_f32 v57, v94, v65, v57
    v_fma_f32 v58, v94, v66, v58
    v_fma_f32 v59, v94, v67, v59
    v_fma_f32 v56, v95, v68, v56
    v_fma_f32 v57, v95, v69, v57
    v_fma_f32 v58, v95, v70, v58
    v_fma_f32 v59, v95, v71, v59
    ds_write_b128 v14, v[56:59] offset:7168
    ds_write_b32 v22, v97 offset:8268
    ds_write_b32 v22, v99 offset:8284
    s_branch L_final
L_predo:
    s_waitcnt vmcnt(0)
    s_mov_b32 s71, s57
    s_cmp_lt_u32 s71, s63
    s_cselect_b32 s77, s65, s66
    s_cselect_b32 s81, s67, s68
    s_cselect_b32 s82, 0, s63
    s_cselect_b32 s83, s3, s5
    s_sub_u32 s77, s77, s71
    s_bfe_u32 s78, s77, 0x60001
    v_readlane_b32 s79, v4, s78
    v_readlane_b32 s80, v5, s78
    s_cmp_lt_u32 s71, s63
    s_cselect_b32 s79, s79, s80
    s_lshl_b32 s80, s79, 16
    s_and_b32 s79, s79, 0xffff0000
    s_bitcmp1_b32 s77, 0
    s_cselect_b32 s79, s79, s80
    s_add_u32 s79, s79, s83
    s_cmp_eq_u32 s71, s82
    s_cselect_b32 s81, s81, 16
    s_cmp_lt_u32 s71, s64
    s_cselect_b32 s81, s81, 0
    s_add_u32 s71, s71, 3
    s_cmp_gt_u32 s81, 0
    s_cselect_b32 s84, s79, 0xf0000000
    s_add_u32 s79, s79, 0x4000
    s_cmp_gt_u32 s81, 4
    s_cselect_b32 s85, s79, 0xf0000000
    s_add_u32 s79, s79, 0x4000
    s_cmp_gt_u32 s81, 8
    s_cselect_b32 s86, s79, 0xf0000000
    s_add_u32 s79, s79, 0x4000
    s_cmp_gt_u32 s81, 12
    s_cselect_b32 s87, s79, 0xf0000000
    buffer_load_dwordx4 v[124:127], v2, s[20:23], s84 offen nt
    buffer_load_dwordx4 v[128:131], v2, s[20:23], s85 offen nt
    buffer_load_dwordx4 v[132:135], v2, s[20:23], s86 offen nt
    buffer_load_dwordx4 v[136:139], v2, s[20:23], s87 offen nt
    buffer_load_dwordx4 v[140:143], v3, s[24:27], s84 offen nt
    buffer_load_dwordx4 v[144:147], v3, s[24:27], s85 offen nt
    buffer_load_dwordx4 v[148:151], v3, s[24:27], s86 offen nt
    buffer_load_dwordx4 v[152:155], v3, s[24:27], s87 offen nt
    s_cmp_lt_u32 s71, s63
    s_cselect_b32 s77, s65, s66
    s_cselect_b32 s81, s67, s68
    s_cselect_b32 s82, 0, s63
    s_cselect_b32 s83, s3, s5
    s_sub_u32 s77, s77, s71
    s_bfe_u32 s78, s77, 0x60001
    v_readlane_b32 s79, v4, s78
    v_readlane_b32 s80, v5, s78
    s_cmp_lt_u32 s71, s63
    s_cselect_b32 s79, s79, s80
    s_lshl_b32 s80, s79, 16
    s_and_b32 s79, s79, 0xffff0000
    s_bitcmp1_b32 s77, 0
    s_cselect_b32 s79, s79, s80
    s_add_u32 s79, s79, s83
    s_cmp_eq_u32 s71, s82
    s_cselect_b32 s81, s81, 16
    s_cmp_lt_u32 s71, s64
    s_cselect_b32 s81, s81, 0
    s_add_u32 s71, s71, 3
    s_cmp_gt_u32 s81, 0
    s_cselect_b32 s84, s79, 0xf0000000
    s_add_u32 s79, s79, 0x4000
    s_cmp_gt_u32 s81, 4
    s_cselect_b32 s85, s79, 0xf0000000
    s_add_u32 s79, s79, 0x4000
    s_cmp_gt_u32 s81, 8
    s_cselect_b32 s86, s79, 0xf0000000
    s_add_u32 s79, s79, 0x4000
    s_cmp_gt_u32 s81, 12
    s_cselect_b32 s87, s79, 0xf0000000
    buffer_load_dwordx4 v[156:159], v2, s[20:23], s84 offen nt
    buffer_load_dwordx4 v[160:163], v2, s[20:23], s85 offen nt
    buffer_load_dwordx4 v[164:167], v2, s[20:23], s86 offen nt
    buffer_load_dwordx4 v[168:171], v2, s[20:23], s87 offen nt
    buffer_load_dwordx4 v[172:175], v3, s[24:27], s84 offen nt
    buffer_load_dwordx4 v[176:179], v3, s[24:27], s85 offen nt
    buffer_load_dwordx4 v[180:183], v3, s[24:27], s86 offen nt
    buffer_load_dwordx4 v[184:187], v3, s[24:27], s87 offen nt
    s_branch L_pgo
L_psw0:
    v_mov_b32 v11, v7
    s_nop 1
    v_permlane32_swap_b32 v7, v11
    s_nop 0
    v_add_f32 v7, v7, v11
    v_mov_b32 v11, v7
    s_nop 1
    v_permlane16_swap_b32 v7, v11
    s_nop 0
    v_add_f32 v7, v7, v11
    ds_write_b128 v21, v[40:43] offset:0
    ds_write_b32 v22, v6 offset:0
    ds_write_b32 v22, v7 offset:16
    s_nop 1
    v_mov_b32 v6, 0xf149f2ca
    v_mov_b32 v7, 0
    v_mov_b32 v40, 0
    v_mov_b32 v41, 0
    v_mov_b32 v42, 0
    v_mov_b32 v43, 0
    v_mov_b32 v24, v28
    v_mov_b32 v25, v29
    v_mov_b32 v26, v30
    v_mov_b32 v27, v31
    s_mov_b32 s76, -1
    s_mov_b32 s73, s63
    s_mov_b32 s74, s68
    s_mov_b32 s75, s70
    s_branch L_pnosw0
L_pmask0:
    v_mov_b32 v11, 0xf149f2ca
    s_sub_u32 s77, s74, 0
    v_cmp_gt_i32 vcc, s77, v20
    s_nop 1
    v_cndmask_b32 v12, v11, v12, vcc
    s_sub_u32 s77, s74, 4
    v_cmp_gt_i32 vcc, s77, v20
    s_nop 1
    v_cndmask_b32 v13, v11, v13, vcc
    s_sub_u32 s77, s74, 8
    v_cmp_gt_i32 vcc, s77, v20
    s_nop 1
    v_cndmask_b32 v14, v11, v14, vcc
    s_sub_u32 s77, s74, 12
    v_cmp_gt_i32 vcc, s77, v20
    s_nop 1
    v_cndmask_b32 v15, v11, v15, vcc
    s_branch L_pnomask0
L_psw1:
    v_mov_b32 v11, v7
    s_nop 1
    v_permlane32_swap_b32 v7, v11
    s_nop 0
    v_add_f32 v7, v7, v11
    v_mov_b32 v11, v7
    s_nop 1
    v_permlane16_swap_b32 v7, v11
    s_nop 0
    v_add_f32 v7, v7, v11
    ds_write_b128 v21, v[40:43] offset:0
    ds_write_b32 v22, v6 offset:0
    ds_write_b32 v22, v7 offset:16
    s_nop 1
    v_mov_b32 v6, 0xf149f2ca
    v_mov_b32 v7, 0
    v_mov_b32 v40, 0
    v_mov_b32 v41, 0
    v_mov_b32 v42, 0
    v_mov_b32 v43, 0
    v_mov_b32 v24, v28
    v_mov_b32 v25, v29
    v_mov_b32 v26, v30
    v_mov_b32 v27, v31
    s_mov_b32 s76, -1
    s_mov_b32 s73, s63
    s_mov_b32 s74, s68
    s_mov_b32 s75, s70
    s_branch L_pnosw1
L_pmask1:
    v_mov_b32 v11, 0xf149f2ca
    s_sub_u32 s77, s74, 0
    v_cmp_gt_i32 vcc, s77, v20
    s_nop 1
    v_cndmask_b32 v12, v11, v12, vcc
    s_sub_u32 s77, s74, 4
    v_cmp_gt_i32 vcc, s77, v20
    s_nop 1
    v_cndmask_b32 v13, v11, v13, vcc
    s_sub_u32 s77, s74, 8
    v_cmp_gt_i32 vcc, s77, v20
    s_nop 1
    v_cndmask_b32 v14, v11, v14, vcc
    s_sub_u32 s77, s74, 12
    v_cmp_gt_i32 vcc, s77, v20
    s_nop 1
    v_cndmask_b32 v15, v11, v15, vcc
    s_branch L_pnomask1
L_pnob:
    v_mov_b32 v11, v7
    s_nop 1
    v_permlane32_swap_b32 v7, v11
    s_nop 0
    v_add_f32 v7, v7, v11
    v_mov_b32 v11, v7
    s_nop 1
    v_permlane16_swap_b32 v7, v11
    s_nop 0
    v_add_f32 v7, v7, v11
    ds_write_b128 v21, v[40:43] offset:0
    ds_write_b32 v22, v6 offset:0
    ds_write_b32 v22, v7 offset:16
    s_nop 1
    v_mov_b32 v6, 0xf149f2ca
    v_mov_b32 v7, 0
    v_mov_b32 v40, 0
    v_mov_b32 v41, 0
    v_mov_b32 v42, 0
    v_mov_b32 v43, 0
    s_nop 1
    s_branch L_pfin
L_sredo:
    s_waitcnt vmcnt(0)
    s_mov_b32 s71, s72
    s_bfe_u32 s78, s71, 0x60001
    v_readlane_b32 s79, v4, s78
    s_lshl_b32 s80, s79, 16
    s_and_b32 s79, s79, 0xffff0000
    s_bitcmp1_b32 s71, 0
    s_cselect_b32 s79, s79, s80
    s_add_u32 s79, s79, s3
    s_cmp_lt_u32 s71, s83
    s_cselect_b32 s84, s79, 0xf0000000
    s_add_u32 s85, s84, 0x4000
    s_add_u32 s86, s84, 0x8000
    s_add_u32 s87, s84, 0xc000
    s_add_u32 s71, s71, 1
    buffer_load_dwordx4 v[124:127], v2, s[20:23], s84 offen
    buffer_load_dwordx4 v[128:131], v2, s[20:23], s85 offen
    buffer_load_dwordx4 v[132:135], v2, s[20:23], s86 offen
    buffer_load_dwordx4 v[136:139], v2, s[20:23], s87 offen
    buffer_load_dwordx4 v[140:143], v3, s[24:27], s84 offen
    buffer_load_dwordx4 v[144:147], v3, s[24:27], s85 offen
    buffer_load_dwordx4 v[148:151], v3, s[24:27], s86 offen
    buffer_load_dwordx4 v[152:155], v3, s[24:27], s87 offen
    s_bfe_u32 s78, s71, 0x60001
    v_readlane_b32 s79, v4, s78
    s_lshl_b32 s80, s79, 16
    s_and_b32 s79, s79, 0xffff0000
    s_bitcmp1_b32 s71, 0
    s_cselect_b32 s79, s79, s80
    s_add_u32 s79, s79, s3
    s_cmp_lt_u32 s71, s83
    s_cselect_b32 s84, s79, 0xf0000000
    s_add_u32 s85, s84, 0x4000
    s_add_u32 s86, s84, 0x8000
    s_add_u32 s87, s84, 0xc000
    s_add_u32 s71, s71, 1
    buffer_load_dwordx4 v[156:159], v2, s[20:23], s84 offen
    buffer_load_dwordx4 v[160:163], v2, s[20:23], s85 offen
    buffer_load_dwordx4 v[164:167], v2, s[20:23], s86 offen
    buffer_load_dwordx4 v[168:171], v2, s[20:23], s87 offen
    buffer_load_dwordx4 v[172:175], v3, s[24:27], s84 offen
    buffer_load_dwordx4 v[176:179], v3, s[24:27], s85 offen
    buffer_load_dwordx4 v[180:183], v3, s[24:27], s86 offen
    buffer_load_dwordx4 v[184:187], v3, s[24:27], s87 offen
    s_branch L_sgo
.section .rodata,"a"
.p2align 6
.amdhsa_kernel standalone__paged_block_table_kv_radixattention__sampling_kernel
  .amdhsa_next_free_vgpr 188
  .amdhsa_next_free_sgpr 102
  .amdhsa_accum_offset 188
  .amdhsa_group_segment_fixed_size 0
  .amdhsa_kernarg_size 64
  .amdhsa_user_sgpr_count 2
  .amdhsa_user_sgpr_kernarg_segment_ptr 1
  .amdhsa_system_sgpr_workgroup_id_x 1
  .amdhsa_float_denorm_mode_32 3
.end_amdhsa_kernel
```
